```python
import torch

def _softmax(x, axis=-1):
    return torch.softmax(x, dim=axis)
def _gelu(x):
    return torch.nn.functional.gelu(x, approximate="tanh")
def _silu(x):
    return torch.nn.functional.silu(x)
def _sigmoid(x):
    return torch.sigmoid(x)
def _layernorm(x, axis=-1, eps=1e-5):
    m = x.mean(dim=axis, keepdim=True)
    v = x.var(dim=axis, keepdim=True, unbiased=False)
    return (x - m) / torch.sqrt(v + eps)
def _scatter_add(tgt, idx, src, axis=0):
    return tgt.clone().index_add_(axis, idx, src)
def _segment_sum(src, seg, n):
    out = torch.zeros((n,) + src.shape[1:], dtype=src.dtype)
    return out.index_add_(0, seg, src)
def _pad(x, pw):
    flat = tuple(v for pair in reversed(pw) for v in pair)
    return torch.nn.functional.pad(x, flat)

kernel_name = 'gather_scatter__edge_featured_mpnn_mpnn__graph'

def setup_inputs():

    _w = (lambda a: (lambda t: t.to(torch.bfloat16) if t.is_floating_point() else t)(torch.as_tensor(a)))
    N, deg, D, De = 10000, 64, 64, max(0, 1)
    E = N * deg
    H = 2 * D
    return {
        "x": _w((lambda *s: torch.randn(*s, dtype=torch.bfloat16) * 0.05)(N, D)),
        "e_attr": _w((lambda *s: torch.randn(*s, dtype=torch.bfloat16) * 1.6)(E, De)),
        "src": _w((lambda lo, hi, *s: torch.randint(lo, hi, s))(0, N, E).to(torch.int64)),
        "dst": _w((lambda lo, hi, *s: torch.randint(lo, hi, s))(0, N, E).to(torch.int64)),
        "w1": _w((lambda *s: torch.randn(*s, dtype=torch.bfloat16) * 1.6)(2 * D + De, H) * (1.0 / (2 * D + De) ** 0.5)),
        "b1": _w((lambda *s: torch.randn(*s, dtype=torch.bfloat16) * 3.2)(H) * 0.01),
        "w2": _w((lambda *s: torch.randn(*s, dtype=torch.bfloat16) * 0.05)(H, D) * (1.0 / H ** 0.5)),
        "b2": _w((lambda *s: torch.randn(*s, dtype=torch.bfloat16) * 0.1)(D) * 0.01),
    }

def reference(x, e_attr, src, dst, w1, b1, w2, b2):
    N, D = x.shape
    h_src = x[src]
    h_dst = x[dst]
    m_in = torch.concatenate([h_src, h_dst, e_attr], axis=-1)
    h = _silu(m_in @ w1 + b1)
    msg = h @ w2 + b2
    return _segment_sum(msg, dst, N)
```

```asm
; @launch kernel=part_kernel grid=(263,1,1) block=(640,1,1) lds=22560
; @launch kernel=main_kernel grid=(256,1,1) block=(512,1,1) lds=101120
.amdgcn_target "amdgcn-amd-amdhsa--gfx950"
.text
.globl part_kernel
.p2align 8
.type part_kernel,@function
part_kernel:
  s_cmp_ge_u32 s2, 263
  s_cbranch_scc1 P_EXIT
  s_cmp_ge_u32 s2, 256
  s_cbranch_scc1 P_PREP
  s_load_dwordx4 s[4:7], s[0:1], 8
  s_load_dwordx2 s[8:9], s[0:1], 24
  s_load_dwordx2 s[10:11], s[0:1], 80
  v_lshlrev_b32 v1, 2, v0
  v_mov_b32 v2, 0
  ds_write_b32 v1, v2
  v_lshlrev_b32 v1, 4, v0
  v_lshlrev_b32 v3, 3, v0
  s_mul_i32 s3, s2, 10000
  s_mul_i32 s28, s2, 5000
  s_mul_i32 s29, s2, 20000
  s_add_u32 s30, s29, 10000
  s_mov_b32 s31, 214749
  s_mov_b32 s32, 0xffff0000
  v_mov_b32 v2, 1
  v_cmp_gt_u32 vcc, 625, v0
  s_nop 0
  s_and_saveexec_b64 s[34:35], vcc
  s_waitcnt lgkmcnt(0)
  s_mov_b32 s16, s8
  s_mov_b32 s17, s9
  s_mov_b32 s18, 2560000
  s_mov_b32 s19, 0x00020000
  buffer_load_dwordx4 v[8:11], v1, s[16:19], s3 offen
  s_mov_b32 s12, s6
  s_mov_b32 s13, s7
  s_mov_b32 s14, 2560000
  s_mov_b32 s15, 0x00020000
  buffer_load_dwordx4 v[4:7], v1, s[12:15], s3 offen
  s_mov_b32 s20, s4
  s_mov_b32 s21, s5
  s_mov_b32 s22, 1280000
  s_mov_b32 s23, 0x00020000
  buffer_load_dwordx2 v[12:13], v3, s[20:23], s28 offen
  s_mov_b32 s24, s10
  s_mov_b32 s25, s11
  s_mov_b32 s26, 7340032
  s_mov_b32 s27, 0x00020000
  s_barrier
  s_waitcnt vmcnt(2)
  v_mul_u32_u24 v14, s31, v8
  v_mul_u32_u24 v15, s31, v9
  v_mul_u32_u24 v16, s31, v10
  v_mul_u32_u24 v17, s31, v11
  v_lshrrev_b32 v14, 21, v14
  v_lshrrev_b32 v15, 21, v15
  v_lshrrev_b32 v16, 21, v16
  v_lshrrev_b32 v17, 21, v17
  v_and_b32 v14, 0x3fc, v14
  ds_add_rtn_u32 v18, v14, v2
  v_and_b32 v15, 0x3fc, v15
  ds_add_rtn_u32 v19, v15, v2
  v_and_b32 v16, 0x3fc, v16
  ds_add_rtn_u32 v20, v16, v2
  v_and_b32 v17, 0x3fc, v17
  ds_add_rtn_u32 v21, v17, v2
  s_waitcnt lgkmcnt(0)
  s_barrier
  v_cmp_gt_u32 vcc, 64, v0
  s_cbranch_vccz P_NOSCAN
  ds_read_b128 v[24:27], v1
  s_and_b32 s33, s2, 7
  s_lshl_b32 s33, s33, 7
  s_lshr_b32 s36, s2, 3
  s_lshl_b32 s36, s36, 2
  s_add_u32 s33, s33, s36
  s_add_u32 s33, s33, 5242880
  v_mul_u32_u24 v41, 4608, v0
  s_waitcnt lgkmcnt(0)
  v_add_u32 v29, v24, v25
  v_add_u32 v30, v29, v26
  v_add_u32 v31, v30, v27
  v_mov_b32 v28, v31
  s_nop 1
  v_add_u32_dpp v28, v28, v28 row_shr:1 row_mask:0xf bank_mask:0xf bound_ctrl:0
  s_nop 1
  v_add_u32_dpp v28, v28, v28 row_shr:2 row_mask:0xf bank_mask:0xf bound_ctrl:0
  s_nop 1
  v_add_u32_dpp v28, v28, v28 row_shr:4 row_mask:0xf bank_mask:0xf bound_ctrl:0
  s_nop 1
  v_add_u32_dpp v28, v28, v28 row_shr:8 row_mask:0xf bank_mask:0xf bound_ctrl:0
  s_nop 1
  v_add_u32_dpp v28, v28, v28 row_bcast:15 row_mask:0xa bank_mask:0xf
  s_nop 1
  v_add_u32_dpp v28, v28, v28 row_bcast:31 row_mask:0xc bank_mask:0xf
  v_sub_u32 v32, v28, v31
  v_add_u32 v33, v32, v24
  v_add_u32 v34, v32, v29
  v_add_u32 v35, v32, v30
  v_mov_b32 v40, 2560
  v_lshl_add_u32 v36, v32, 3, v40
  v_lshl_add_u32 v37, v33, 3, v40
  v_lshl_add_u32 v38, v34, 3, v40
  v_lshl_add_u32 v39, v35, 3, v40
  ds_write_b128 v1, v[36:39] offset:1024
  v_lshl_or_b32 v32, v24, 16, v32
  v_lshl_or_b32 v33, v25, 16, v33
  v_lshl_or_b32 v34, v26, 16, v34
  v_lshl_or_b32 v35, v27, 16, v35
  s_waitcnt lgkmcnt(0)
  s_barrier
  buffer_store_dword v32, v41, s[24:27], s33 offen offset:0
  buffer_store_dword v33, v41, s[24:27], s33 offen offset:1152
  buffer_store_dword v34, v41, s[24:27], s33 offen offset:2304
  buffer_store_dword v35, v41, s[24:27], s33 offen offset:3456
  ds_read_b32 v14, v14 offset:1024
  ds_read_b32 v15, v15 offset:1024
  ds_read_b32 v16, v16 offset:1024
  ds_read_b32 v17, v17 offset:1024
  s_waitcnt vmcnt(4)
  s_branch P_PACK
P_NOSCAN:
  s_barrier
  ds_read_b32 v14, v14 offset:1024
  ds_read_b32 v15, v15 offset:1024
  ds_read_b32 v16, v16 offset:1024
  ds_read_b32 v17, v17 offset:1024
  s_waitcnt vmcnt(0)
P_PACK:
  v_lshl_or_b32 v4, v12, 16, v4
  v_and_or_b32 v5, v12, s32, v5
  v_lshl_or_b32 v6, v13, 16, v6
  v_and_or_b32 v7, v13, s32, v7
  s_waitcnt lgkmcnt(3)
  v_lshl_add_u32 v14, v18, 3, v14
  s_waitcnt lgkmcnt(2)
  v_lshl_add_u32 v15, v19, 3, v15
  s_waitcnt lgkmcnt(1)
  v_lshl_add_u32 v16, v20, 3, v16
  s_waitcnt lgkmcnt(0)
  v_lshl_add_u32 v17, v21, 3, v17
  ds_write2_b32 v14, v4, v8 offset0:0 offset1:1
  ds_write2_b32 v15, v5, v9 offset0:0 offset1:1
  ds_write2_b32 v16, v6, v10 offset0:0 offset1:1
  ds_write2_b32 v17, v7, v11 offset0:0 offset1:1
  s_waitcnt lgkmcnt(0)
  s_barrier
  ds_read_b128 v[4:7], v1 offset:2560
  ds_read_b128 v[8:11], v1 offset:12560
  s_waitcnt lgkmcnt(1)
  buffer_store_dwordx4 v[4:7], v1, s[24:27], s29 offen
  s_waitcnt lgkmcnt(0)
  buffer_store_dwordx4 v[8:11], v1, s[24:27], s30 offen
P_EXIT:
  s_endpgm
P_CST:
  s_load_dwordx4 s[4:7], s[0:1], 32
  s_load_dwordx2 s[8:9], s[0:1], 56
  s_load_dwordx2 s[10:11], s[0:1], 80
  v_cmp_gt_u32 vcc, 64, v0
  s_cbranch_vccz P_EXIT
  v_and_b32 v1, 31, v0
  v_lshlrev_b32 v1, 1, v1
  v_lshlrev_b32 v2, 2, v0
  s_mov_b32 s31, 0xBFB8AA3B
  s_mov_b32 s30, 32768
  s_waitcnt lgkmcnt(0)
  s_mov_b32 s24, s10
  s_mov_b32 s25, s11
  s_mov_b32 s26, 7340032
  s_mov_b32 s27, 0x00020000
  s_mov_b32 s12, s4
  s_mov_b32 s13, s5
  s_mov_b32 s14, 33024
  s_mov_b32 s15, 0x00020000
  s_mov_b32 s16, s6
  s_mov_b32 s17, s7
  s_mov_b32 s18, 256
  s_mov_b32 s19, 0x00020000
  s_mov_b32 s20, s8
  s_mov_b32 s21, s9
  s_mov_b32 s22, 128
  s_mov_b32 s23, 0x00020000
  buffer_load_ushort v4, v1, s[12:15], s30 offen offset:0
  buffer_load_ushort v5, v1, s[12:15], s30 offen offset:64
  buffer_load_ushort v6, v1, s[12:15], s30 offen offset:128
  buffer_load_ushort v7, v1, s[12:15], s30 offen offset:192
  buffer_load_dword v8, v2, s[16:19], 0 offen
  buffer_load_dword v10, v2, s[20:23], 0 offen
  v_cmp_lt_u32 vcc, 31, v0
  s_waitcnt vmcnt(0)
  v_lshlrev_b32 v4, 16, v4
  v_mul_f32 v4, s31, v4
  v_cvt_pk_bf16_f32 v12, 0, v4
  v_sub_f32 v4, v4, v12
  v_cvt_pk_bf16_f32 v4, 0, v4
  v_cndmask_b32 v4, v12, v4, vcc
  v_lshlrev_b32 v5, 16, v5
  v_mul_f32 v5, s31, v5
  v_cvt_pk_bf16_f32 v12, 0, v5
  v_sub_f32 v5, v5, v12
  v_cvt_pk_bf16_f32 v5, 0, v5
  v_cndmask_b32 v5, v12, v5, vcc
  v_lshlrev_b32 v6, 16, v6
  v_mul_f32 v6, s31, v6
  v_cvt_pk_bf16_f32 v12, 0, v6
  v_sub_f32 v6, v6, v12
  v_cvt_pk_bf16_f32 v6, 0, v6
  v_cndmask_b32 v6, v12, v6, vcc
  v_lshlrev_b32 v7, 16, v7
  v_mul_f32 v7, s31, v7
  v_cvt_pk_bf16_f32 v12, 0, v7
  v_sub_f32 v7, v7, v12
  v_cvt_pk_bf16_f32 v7, 0, v7
  v_cndmask_b32 v7, v12, v7, vcc
  v_and_b32 v9, 0xffff0000, v8
  v_lshlrev_b32 v8, 16, v8
  v_mul_f32 v8, s31, v8
  v_mul_f32 v9, s31, v9
  v_lshlrev_b32 v1, 4, v0
  v_lshlrev_b32 v3, 3, v0
  s_mov_b32 s30, 5816320
  buffer_store_dwordx4 v[4:7], v1, s[24:27], s30 offen
  buffer_store_dwordx2 v[8:9], v3, s[24:27], s30 offen offset:1024
  buffer_store_dword v10, v2, s[24:27], s30 offen offset:1536
  s_endpgm
P_PREP:
  s_cmp_eq_u32 s2, 262
  s_cbranch_scc1 P_CST
  s_load_dwordx2 s[4:5], s[0:1], 32
  s_load_dwordx2 s[6:7], s[0:1], 48
  s_load_dwordx2 s[10:11], s[0:1], 80
  v_cmp_gt_u32 vcc, 512, v0
  s_cbranch_vccz P_EXIT
  s_sub_u32 s3, s2, 256
  s_and_b32 s28, s3, 1
  s_lshl_b32 s28, s28, 9
  v_add_u32 v1, s28, v0
  s_lshr_b32 s29, s3, 1
  s_lshl_b32 s30, s29, 14
  s_add_u32 s30, s30, 5767168
  s_mov_b32 s31, 1.0
  s_cmp_eq_u32 s29, 0
  s_cselect_b32 s31, 0xBFB8AA3B, s31
  s_waitcnt lgkmcnt(0)
  s_mov_b32 s24, s10
  s_mov_b32 s25, s11
  s_mov_b32 s26, 7340032
  s_mov_b32 s27, 0x00020000
  s_mov_b32 s12, s4
  s_mov_b32 s13, s5
  s_mov_b32 s14, 33024
  s_mov_b32 s15, 0x00020000
  s_mov_b32 s16, s6
  s_mov_b32 s17, s7
  s_mov_b32 s18, 16384
  s_mov_b32 s19, 0x00020000
  s_cmp_eq_u32 s29, 2
  s_cbranch_scc1 P_PREP2
  s_cmp_eq_u32 s29, 0
  s_cbranch_scc1 P_PREP0
  v_bfe_u32 v2, v1, 4, 2
  v_bfe_u32 v3, v1, 6, 1
  v_lshlrev_b32 v2, 11, v2
  v_lshl_add_u32 v2, v3, 13, v2
  v_lshrrev_b32 v3, 7, v1
  v_lshl_add_u32 v2, v3, 5, v2
  v_and_b32 v3, 15, v1
  s_branch P_PREP1
P_PREP0:
  v_bfe_u32 v2, v1, 5, 1
  v_bfe_u32 v3, v1, 6, 2
  v_lshlrev_b32 v2, 13, v2
  v_lshl_add_u32 v2, v3, 11, v2
  v_lshrrev_b32 v3, 8, v1
  v_lshl_add_u32 v2, v3, 6, v2
  v_and_b32 v3, 31, v1
P_PREP1:
  v_lshl_add_u32 v2, v3, 1, v2
  s_lshl_b32 s32, s29, 14
  buffer_load_ushort v8, v2, s[12:15], s32 offen offset:0
  buffer_load_ushort v9, v2, s[12:15], s32 offen offset:256
  buffer_load_ushort v10, v2, s[12:15], s32 offen offset:512
  buffer_load_ushort v11, v2, s[12:15], s32 offen offset:768
  buffer_load_ushort v12, v2, s[12:15], s32 offen offset:1024
  buffer_load_ushort v13, v2, s[12:15], s32 offen offset:1280
  buffer_load_ushort v14, v2, s[12:15], s32 offen offset:1536
  buffer_load_ushort v15, v2, s[12:15], s32 offen offset:1792
  s_branch P_PREP3
P_PREP2:
  v_bfe_u32 v2, v1, 4, 2
  v_bfe_u32 v3, v1, 6, 2
  v_lshlrev_b32 v2, 10, v2
  v_lshl_add_u32 v2, v3, 12, v2
  v_lshrrev_b32 v3, 8, v1
  v_lshl_add_u32 v2, v3, 5, v2
  v_and_b32 v3, 15, v1
  v_lshl_add_u32 v2, v3, 1, v2
  buffer_load_ushort v8, v2, s[16:19], 0 offen offset:0
  buffer_load_ushort v9, v2, s[16:19], 0 offen offset:128
  buffer_load_ushort v10, v2, s[16:19], 0 offen offset:256
  buffer_load_ushort v11, v2, s[16:19], 0 offen offset:384
  buffer_load_ushort v12, v2, s[16:19], 0 offen offset:512
  buffer_load_ushort v13, v2, s[16:19], 0 offen offset:640
  buffer_load_ushort v14, v2, s[16:19], 0 offen offset:768
  buffer_load_ushort v15, v2, s[16:19], 0 offen offset:896
P_PREP3:
  v_lshlrev_b32 v1, 4, v1
  s_waitcnt vmcnt(0)
  v_lshlrev_b32 v8, 16, v8
  v_lshlrev_b32 v9, 16, v9
  v_lshlrev_b32 v10, 16, v10
  v_lshlrev_b32 v11, 16, v11
  v_lshlrev_b32 v12, 16, v12
  v_lshlrev_b32 v13, 16, v13
  v_lshlrev_b32 v14, 16, v14
  v_lshlrev_b32 v15, 16, v15
  v_mul_f32 v8, s31, v8
  v_mul_f32 v9, s31, v9
  v_mul_f32 v10, s31, v10
  v_mul_f32 v11, s31, v11
  v_mul_f32 v12, s31, v12
  v_mul_f32 v13, s31, v13
  v_mul_f32 v14, s31, v14
  v_mul_f32 v15, s31, v15
  v_cvt_pk_bf16_f32 v4, v8, v9
  v_cvt_pk_bf16_f32 v5, v10, v11
  v_cvt_pk_bf16_f32 v6, v12, v13
  v_cvt_pk_bf16_f32 v7, v14, v15
  buffer_store_dwordx4 v[4:7], v1, s[24:27], s30 offen
  s_endpgm
.globl main_kernel
.p2align 8
.type main_kernel,@function
main_kernel:
  s_cmp_ge_u32 s2, 256
  s_cbranch_scc1 M_EXIT
  s_load_dwordx2 s[52:53], s[0:1], 80
  s_load_dwordx2 s[54:55], s[0:1], 0
  s_load_dwordx2 s[46:47], s[0:1], 64
  v_and_b32 v1, 63, v0
  v_lshrrev_b32 v2, 6, v0
  s_nop 0
  v_readfirstlane_b32 s30, v2
  s_and_b32 s3, s2, 7
  s_lshl_b32 s3, s3, 5
  s_lshr_b32 s28, s2, 3
  s_or_b32 s3, s3, s28
  s_mul_i32 s28, s3, 625
  s_add_u32 s29, s28, 640
  s_add_u32 s28, s28, 15
  s_lshr_b32 s28, s28, 4
  s_lshr_b32 s29, s29, 4
  s_sub_u32 s29, s29, s28
  s_mov_b32 s31, 0
  s_mov_b32 s32, 0
  s_mov_b32 s36, 128
  s_mov_b32 s49, 0
  s_mov_b32 s50, 0
  s_mov_b32 s51, 28
  s_mov_b32 s39, 0x71800000
  v_and_b32 v2, 31, v1
  v_lshlrev_b32 v12, 2, v2
  v_add_u32 v12, 0, v12
  s_waitcnt lgkmcnt(0)
  s_mov_b32 s8, s52
  s_mov_b32 s9, s53
  s_mov_b32 s10, 7340032
  s_mov_b32 s11, 0x00020000
  s_mov_b32 s4, s54
  s_mov_b32 s5, s55
  s_mov_b32 s6, 1280000
  s_mov_b32 s7, 0x00020000
  s_mov_b32 s16, s46
  s_mov_b32 s17, s47
  s_mov_b32 s18, 1280000
  s_mov_b32 s19, 0x00020000
  v_lshrrev_b32 v2, 3, v0
  v_lshlrev_b32 v30, 4, v2
  s_mul_i32 s40, s3, 1152
  s_add_u32 s40, s40, 5242880
  buffer_load_dwordx4 v[20:23], v30, s[8:11], s40 offen
  v_lshrrev_b32 v17, 5, v1
  v_lshlrev_b32 v4, 6, v17
  v_lshrrev_b32 v31, 3, v1
  v_and_b32 v5, 7, v1
  v_xor_b32 v5, v5, v31
  v_lshlrev_b32 v5, 4, v5
  v_lshl_add_u32 v5, v31, 7, v5
  s_lshl_b32 s45, s30, 10
  s_add_u32 m0, s45, 79616
  s_lshl_b32 s44, s28, 7
  s_add_u32 s45, s45, s44
  s_lshl_b32 s44, s30, 11
  s_add_u32 s44, s44, 84736
  s_cmp_lt_u32 s30, 5
  s_cselect_b32 s45, s45, 0x40000000
  s_cselect_b32 m0, m0, s44
  v_add_u32 v5, s45, v5
  v_lshlrev_b32 v6, 4, v1
  buffer_load_dwordx4 v5, s[4:7], 0 offen lds
  s_lshl_b32 s44, s30, 11
  s_add_u32 s44, s44, 5783552
  v_and_b32 v31, 15, v1
  v_lshlrev_b32 v31, 2, v31
  s_lshl_b32 s45, s30, 6
  s_add_u32 s45, s45, 5817344
  buffer_load_dwordx4 a[80:83], v6, s[8:11], s44 offen offset:0
  buffer_load_dwordx4 a[84:87], v6, s[8:11], s44 offen offset:1024
  buffer_load_dword v116, v31, s[8:11], s45 offen
  s_mov_b32 s44, 5816320
  buffer_load_dwordx4 v[108:111], v6, s[8:11], s44 offen
  v_lshlrev_b32 v3, 4, v0
  v_mov_b32 v92, 0
  v_mov_b32 v93, 0
  v_mov_b32 v94, 0
  v_mov_b32 v95, 0
  v_mov_b32 v96, 0x8000
  v_mov_b32 v97, 0x8000
  v_mov_b32 v98, 0x8000
  v_mov_b32 v99, 0x8000
  v_mov_b32 v100, 2802864768
  v_mov_b32 v101, 2802864768
  v_mov_b32 v102, 2802864768
  v_mov_b32 v103, 2802864768
  v_add_u32 v2, 60800, v3
  ds_write_b128 v2, v[96:99] offset:0
  ds_write_b128 v2, v[96:99] offset:8192
  v_cmp_gt_u32 vcc, 8, v0
  s_nop 0
  s_mov_b64 exec, vcc
  ds_write_b128 v2, v[96:99] offset:16384
  s_mov_b64 exec, -1
  v_add_u32 v2, 21120, v3
  ds_write_b128 v2, v[92:95] offset:0
  ds_write_b128 v2, v[92:95] offset:8192
  ds_write_b128 v2, v[92:95] offset:16384
  ds_write_b128 v2, v[92:95] offset:24576
  v_cmp_gt_u32 vcc, 411, v0
  s_nop 0
  s_mov_b64 exec, vcc
  ds_write_b128 v2, v[92:95] offset:32768
  s_mov_b64 exec, -1
  v_add_u32 v2, 77312, v3
  v_cmp_gt_u32 vcc, 144, v0
  s_nop 0
  s_mov_b64 exec, vcc
  ds_write_b128 v2, v[100:103] offset:0
  s_mov_b64 exec, -1
  v_bfe_u32 v2, v0, 3, 3
  v_lshlrev_b32 v2, 5, v2
  v_add_u32 v2, s30, v2
  v_mul_u32_u24 v30, 20000, v2
  v_and_b32 v2, 7, v0
  v_lshl_add_u32 v30, v2, 4, v30
  v_lshlrev_b32 v2, 1, v2
  v_sub_u32 v31, s51, v2
  v_add_u32 v2, s31, v2
  s_lshl_b32 s40, s31, 3
  v_mov_b32 v114, 0
  s_waitcnt vmcnt(5)
  v_and_b32 v26, 0xffff, v20
  v_lshrrev_b32 v20, 16, v20
  v_lshl_add_u32 v26, v26, 3, v30
  v_sub_u32 v20, v20, v2
  v_max_i32 v114, v114, v20
  v_min_i32 v20, v20, v31
  v_cmp_lt_i32_e64 s[52:53], 0, v20
  v_cmp_lt_i32_e64 s[54:55], 1, v20
  v_cmp_lt_i32_e64 s[56:57], 16, v20
  v_cmp_lt_i32_e64 s[58:59], 17, v20
  v_and_b32 v27, 0xffff, v21
  v_lshrrev_b32 v21, 16, v21
  v_lshl_add_u32 v27, v27, 3, v30
  v_sub_u32 v21, v21, v2
  v_max_i32 v114, v114, v21
  v_min_i32 v21, v21, v31
  v_cmp_lt_i32_e64 s[60:61], 0, v21
  v_cmp_lt_i32_e64 s[62:63], 1, v21
  v_cmp_lt_i32_e64 s[64:65], 16, v21
  v_cmp_lt_i32_e64 s[66:67], 17, v21
  v_and_b32 v28, 0xffff, v22
  v_lshrrev_b32 v22, 16, v22
  v_lshl_add_u32 v28, v28, 3, v30
  v_sub_u32 v22, v22, v2
  v_max_i32 v114, v114, v22
  v_min_i32 v22, v22, v31
  v_cmp_lt_i32_e64 s[68:69], 0, v22
  v_cmp_lt_i32_e64 s[70:71], 1, v22
  v_cmp_lt_i32_e64 s[72:73], 16, v22
  v_cmp_lt_i32_e64 s[74:75], 17, v22
  v_and_b32 v29, 0xffff, v23
  v_lshrrev_b32 v23, 16, v23
  v_lshl_add_u32 v29, v29, 3, v30
  v_sub_u32 v23, v23, v2
  v_max_i32 v114, v114, v23
  v_min_i32 v23, v23, v31
  v_cmp_lt_i32_e64 s[76:77], 0, v23
  v_cmp_lt_i32_e64 s[78:79], 1, v23
  v_cmp_lt_i32_e64 s[80:81], 16, v23
  v_cmp_lt_i32_e64 s[82:83], 17, v23
  v_mov_b32 v2, 0x40000000
  v_cndmask_b32_e64 v30, v2, v26, s[52:53]
  buffer_load_dwordx4 v[60:63], v30, s[8:11], s40 offen offset:0
  v_cndmask_b32_e64 v31, v2, v26, s[56:57]
  buffer_load_dwordx4 v[64:67], v31, s[8:11], s40 offen offset:128
  s_add_u32 s40, s40, 160000
  v_cndmask_b32_e64 v30, v2, v27, s[60:61]
  buffer_load_dwordx4 v[68:71], v30, s[8:11], s40 offen offset:0
  v_cndmask_b32_e64 v31, v2, v27, s[64:65]
  buffer_load_dwordx4 v[72:75], v31, s[8:11], s40 offen offset:128
  s_add_u32 s40, s40, 160000
  v_cndmask_b32_e64 v30, v2, v28, s[68:69]
  buffer_load_dwordx4 v[76:79], v30, s[8:11], s40 offen offset:0
  v_cndmask_b32_e64 v31, v2, v28, s[72:73]
  buffer_load_dwordx4 v[80:83], v31, s[8:11], s40 offen offset:128
  s_add_u32 s40, s40, 160000
  v_cndmask_b32_e64 v30, v2, v29, s[76:77]
  buffer_load_dwordx4 v[84:87], v30, s[8:11], s40 offen offset:0
  v_cndmask_b32_e64 v31, v2, v29, s[80:81]
  buffer_load_dwordx4 v[88:91], v31, s[8:11], s40 offen offset:128
  s_lshl_b32 s40, s30, 11
  s_add_u32 s44, s40, 84736
  s_add_u32 s40, s40, 5767168
  s_mov_b32 m0, s44
  s_nop 0
  buffer_load_dwordx4 v6, s[8:11], s40 offen offset:0 lds
  buffer_load_dwordx4 v6, s[8:11], s40 offen offset:1024 lds
  v_and_b32 v3, 1, v1
  v_bfe_u32 v30, v1, 2, 1
  v_lshl_or_b32 v30, v30, 1, v3
  v_lshlrev_b32 v31, 1, v17
  v_mov_b32 v34, 0x3f803f80
  v_cmp_eq_u32 vcc, v30, v31
  s_nop 1
  v_cndmask_b32 v10, 0, v34, vcc
  v_add_u32 v31, 1, v31
  v_cmp_eq_u32 vcc, v30, v31
  s_nop 1
  v_cndmask_b32 v11, 0, v34, vcc
  s_waitcnt vmcnt(10)
  v_mov_b32 v44, v108
  v_mov_b32 v47, 0
  v_mov_b32 v48, v109
  v_mov_b32 v51, 0
  v_mov_b32 v52, v110
  v_mov_b32 v55, 0
  v_mov_b32 v56, v111
  v_mov_b32 v59, 0
  s_waitcnt lgkmcnt(0)
  s_barrier
  v_and_b32 v2, 7, v1
  v_lshrrev_b32 v3, 4, v1
  v_xor_b32 v2, v2, v3
  v_and_b32 v30, 15, v1
  v_lshlrev_b32 v31, 7, v30
  v_add_u32 v31, 79616, v31
  v_lshl_add_u32 v32, v2, 4, v31
  v_xor_b32 v33, 64, v32
  ds_read_b128 a[0:3], v32 offset:0
  ds_read_b128 a[4:7], v33 offset:0
  ds_read_b128 a[8:11], v32 offset:2048
  ds_read_b128 a[12:15], v33 offset:2048
  ds_read_b128 a[16:19], v32 offset:4096
  ds_read_b128 a[20:23], v33 offset:4096
  s_mov_b32 s46, 3216550459
  s_lshl_b32 s47, s30, 6
  v_mul_u32_u24 v3, 2112, v3
  v_lshl_add_u32 v30, v30, 2, v3
  v_add_u32 v30, s47, v30
  s_waitcnt lgkmcnt(5)
  v_mfma_f32_16x16x32_bf16 v[92:95], a[0:3], a[80:83], 0
  s_waitcnt lgkmcnt(4)
  v_mfma_f32_16x16x32_bf16 v[92:95], a[4:7], a[84:87], v[92:95]
  s_waitcnt lgkmcnt(3)
  v_mfma_f32_16x16x32_bf16 v[96:99], a[8:11], a[80:83], 0
  s_waitcnt lgkmcnt(2)
  v_mfma_f32_16x16x32_bf16 v[96:99], a[12:15], a[84:87], v[96:99]
  s_waitcnt lgkmcnt(1)
  v_mfma_f32_16x16x32_bf16 v[100:103], a[16:19], a[80:83], 0
  s_waitcnt lgkmcnt(0)
  v_mfma_f32_16x16x32_bf16 v[100:103], a[20:23], a[84:87], v[100:103]
  v_fma_f32 v92, v92, s46, v116
  v_cvt_pk_bf16_f32 v32, 0, v92
  v_sub_f32 v32, v92, v32
  v_cvt_pk_bf16_f32 v92, v32, v92
  ds_write_b32 v30, v92 offset:0
  v_fma_f32 v93, v93, s46, v116
  v_cvt_pk_bf16_f32 v33, 0, v93
  v_sub_f32 v33, v93, v33
  v_cvt_pk_bf16_f32 v93, v33, v93
  ds_write_b32 v30, v93 offset:528
  v_fma_f32 v94, v94, s46, v116
  v_cvt_pk_bf16_f32 v32, 0, v94
  v_sub_f32 v32, v94, v32
  v_cvt_pk_bf16_f32 v94, v32, v94
  ds_write_b32 v30, v94 offset:1056
  v_fma_f32 v95, v95, s46, v116
  v_cvt_pk_bf16_f32 v33, 0, v95
  v_sub_f32 v33, v95, v33
  v_cvt_pk_bf16_f32 v95, v33, v95
  ds_write_b32 v30, v95 offset:1584
  v_fma_f32 v96, v96, s46, v116
  v_cvt_pk_bf16_f32 v32, 0, v96
  v_sub_f32 v32, v96, v32
  v_cvt_pk_bf16_f32 v96, v32, v96
  ds_write_b32 v30, v96 offset:8448
  v_fma_f32 v97, v97, s46, v116
  v_cvt_pk_bf16_f32 v33, 0, v97
  v_sub_f32 v33, v97, v33
  v_cvt_pk_bf16_f32 v97, v33, v97
  ds_write_b32 v30, v97 offset:8976
  v_fma_f32 v98, v98, s46, v116
  v_cvt_pk_bf16_f32 v32, 0, v98
  v_sub_f32 v32, v98, v32
  v_cvt_pk_bf16_f32 v98, v32, v98
  ds_write_b32 v30, v98 offset:9504
  v_fma_f32 v99, v99, s46, v116
  v_cvt_pk_bf16_f32 v33, 0, v99
  v_sub_f32 v33, v99, v33
  v_cvt_pk_bf16_f32 v99, v33, v99
  ds_write_b32 v30, v99 offset:10032
  s_mov_b32 exec_hi, 0
  v_fma_f32 v100, v100, s46, v116
  v_cvt_pk_bf16_f32 v32, 0, v100
  v_sub_f32 v32, v100, v32
  v_cvt_pk_bf16_f32 v100, v32, v100
  ds_write_b32 v30, v100 offset:16896
  v_fma_f32 v101, v101, s46, v116
  v_cvt_pk_bf16_f32 v33, 0, v101
  v_sub_f32 v33, v101, v33
  v_cvt_pk_bf16_f32 v101, v33, v101
  ds_write_b32 v30, v101 offset:17424
  v_fma_f32 v102, v102, s46, v116
  v_cvt_pk_bf16_f32 v32, 0, v102
  v_sub_f32 v32, v102, v32
  v_cvt_pk_bf16_f32 v102, v32, v102
  ds_write_b32 v30, v102 offset:17952
  v_fma_f32 v103, v103, s46, v116
  v_cvt_pk_bf16_f32 v33, 0, v103
  v_sub_f32 v33, v103, v33
  v_cvt_pk_bf16_f32 v103, v33, v103
  ds_write_b32 v30, v103 offset:18480
  s_mov_b64 exec, -1
M_BDONE:
  s_lshl_b32 s41, s30, 2
  v_bfe_u32 v30, v1, 2, 1
  v_and_b32 v31, 1, v1
  v_lshl_or_b32 v30, v30, 1, v31
  v_add_u32 v14, s41, v30
  v_bfe_u32 v30, v1, 3, 2
  v_bfe_u32 v31, v1, 1, 1
  v_lshl_or_b32 v30, v31, 2, v30
  v_lshlrev_b32 v113, 2, v30
  v_add_u32 v113, 60800, v113
  s_lshl_b32 s41, s30, 4
  s_add_u32 s41, s41, 77312
  v_lshrrev_b32 v30, 5, v1
  v_lshl_add_u32 v15, v30, 3, s41
  v_mov_b32 v18, 0
  v_mov_b32 v19, 0
  v_mov_b32 v20, 1.0
  v_mov_b32 v21, 1.0
  v_mov_b32 v8, 1.0
  v_mov_b32 v9, 1.0
  v_mov_b32 v39, 0
  v_mov_b32 v43, 0
  v_mov_b32 v116, 0
  v_mov_b32 v117, 0
  v_mov_b32 v118, 0
  v_mov_b32 v119, 0
  v_mov_b32 v120, 0
  v_mov_b32 v121, 0
  v_mov_b32 v122, 0
  v_mov_b32 v123, 0
  s_lshl_b32 s40, s28, 2
  s_sub_u32 s40, 60192, s40
  v_mov_b32 v2, 1
  v_mov_b32 v31, 60448
  v_cmp_lt_i32 vcc, s51, v114
  s_nop 0
  s_mov_b64 exec, vcc
  ds_write_b32 v31, v2
  s_waitcnt vmcnt(9)
  s_mov_b64 exec, s[52:53]
  v_lshl_add_u32 v61, v61, 2, s40
  ds_add_rtn_u32 v92, v61, v2
  s_mov_b64 exec, s[54:55]
  v_lshl_add_u32 v63, v63, 2, s40
  ds_add_rtn_u32 v93, v63, v2
  s_cmp_eq_u64 s[56:57], 0
  s_cbranch_scc1 M_SKA0
  s_waitcnt vmcnt(8)
  s_mov_b64 exec, s[56:57]
  v_lshl_add_u32 v65, v65, 2, s40
  ds_add_rtn_u32 v94, v65, v2
  s_mov_b64 exec, s[58:59]
  v_lshl_add_u32 v67, v67, 2, s40
  ds_add_rtn_u32 v95, v67, v2
M_SKA0:
  s_waitcnt vmcnt(7)
  s_mov_b64 exec, s[60:61]
  v_lshl_add_u32 v69, v69, 2, s40
  ds_add_rtn_u32 v96, v69, v2
  s_mov_b64 exec, s[62:63]
  v_lshl_add_u32 v71, v71, 2, s40
  ds_add_rtn_u32 v97, v71, v2
  s_cmp_eq_u64 s[64:65], 0
  s_cbranch_scc1 M_SKA1
  s_waitcnt vmcnt(6)
  s_mov_b64 exec, s[64:65]
  v_lshl_add_u32 v73, v73, 2, s40
  ds_add_rtn_u32 v98, v73, v2
  s_mov_b64 exec, s[66:67]
  v_lshl_add_u32 v75, v75, 2, s40
  ds_add_rtn_u32 v99, v75, v2
M_SKA1:
  s_waitcnt vmcnt(5)
  s_mov_b64 exec, s[68:69]
  v_lshl_add_u32 v77, v77, 2, s40
  ds_add_rtn_u32 v100, v77, v2
  s_mov_b64 exec, s[70:71]
  v_lshl_add_u32 v79, v79, 2, s40
  ds_add_rtn_u32 v101, v79, v2
  s_cmp_eq_u64 s[72:73], 0
  s_cbranch_scc1 M_SKA2
  s_waitcnt vmcnt(4)
  s_mov_b64 exec, s[72:73]
  v_lshl_add_u32 v81, v81, 2, s40
  ds_add_rtn_u32 v102, v81, v2
  s_mov_b64 exec, s[74:75]
  v_lshl_add_u32 v83, v83, 2, s40
  ds_add_rtn_u32 v103, v83, v2
M_SKA2:
  s_waitcnt vmcnt(3)
  s_mov_b64 exec, s[76:77]
  v_lshl_add_u32 v85, v85, 2, s40
  ds_add_rtn_u32 v104, v85, v2
  s_mov_b64 exec, s[78:79]
  v_lshl_add_u32 v87, v87, 2, s40
  ds_add_rtn_u32 v105, v87, v2
  s_cmp_eq_u64 s[80:81], 0
  s_cbranch_scc1 M_SKA3
  s_waitcnt vmcnt(2)
  s_mov_b64 exec, s[80:81]
  v_lshl_add_u32 v89, v89, 2, s40
  ds_add_rtn_u32 v106, v89, v2
  s_mov_b64 exec, s[82:83]
  v_lshl_add_u32 v91, v91, 2, s40
  ds_add_rtn_u32 v107, v91, v2
M_SKA3:
  s_mov_b64 exec, -1
  v_lshlrev_b32 v3, 2, v1
  v_add_u32 v3, 60192, v3
  s_waitcnt lgkmcnt(0)
  s_barrier
  ds_read_b32 v17, v3
  v_mov_b32 v31, 60448
  ds_read_b32 v31, v31
  s_waitcnt lgkmcnt(1)
  v_add_u32 v30, 7, v17
  v_lshrrev_b32 v30, 3, v30
  v_mov_b32 v2, v30
  s_nop 1
  v_add_u32_dpp v2, v2, v2 row_shr:1 row_mask:0xf bank_mask:0xf bound_ctrl:0
  s_nop 1
  v_add_u32_dpp v2, v2, v2 row_shr:2 row_mask:0xf bank_mask:0xf bound_ctrl:0
  s_nop 1
  v_add_u32_dpp v2, v2, v2 row_shr:4 row_mask:0xf bank_mask:0xf bound_ctrl:0
  s_nop 1
  v_add_u32_dpp v2, v2, v2 row_shr:8 row_mask:0xf bank_mask:0xf bound_ctrl:0
  s_nop 1
  v_add_u32_dpp v2, v2, v2 row_bcast:15 row_mask:0xa bank_mask:0xf
  s_nop 1
  v_add_u32_dpp v2, v2, v2 row_bcast:31 row_mask:0xc bank_mask:0xf
  s_nop 0
  v_readlane_b32 s33, v2, 63
  v_sub_u32 v2, v2, v30
  v_mov_b32 v32, 60800
  v_lshl_add_u32 v32, v2, 5, v32
  ds_write_b32 v3, v32 offset:272
  s_add_u32 s33, s33, 31
  s_lshr_b32 s33, s33, 5
  s_max_u32 s42, s33, 1
  v_cvt_f32_u32 v35, s42
  v_rcp_f32 v35, v35
  s_waitcnt lgkmcnt(0)
  v_readfirstlane_b32 s35, v31
  s_cmp_gt_u32 s33, 16
  s_cselect_b32 s42, 1, s35
  s_andn2_b32 s42, s42, s32
  s_cbranch_scc1 M_SLOW
  s_mov_b64 exec, s[52:53]
  ds_read_b32 v61, v61 offset:272
  s_mov_b64 exec, s[54:55]
  ds_read_b32 v63, v63 offset:272
  s_cmp_eq_u64 s[56:57], 0
  s_cbranch_scc1 M_SKB0
  s_mov_b64 exec, s[56:57]
  ds_read_b32 v65, v65 offset:272
  s_mov_b64 exec, s[58:59]
  ds_read_b32 v67, v67 offset:272
M_SKB0:
  s_mov_b64 exec, s[60:61]
  ds_read_b32 v69, v69 offset:272
  s_mov_b64 exec, s[62:63]
  ds_read_b32 v71, v71 offset:272
  s_cmp_eq_u64 s[64:65], 0
  s_cbranch_scc1 M_SKB1
  s_mov_b64 exec, s[64:65]
  ds_read_b32 v73, v73 offset:272
  s_mov_b64 exec, s[66:67]
  ds_read_b32 v75, v75 offset:272
M_SKB1:
  s_mov_b64 exec, s[68:69]
  ds_read_b32 v77, v77 offset:272
  s_mov_b64 exec, s[70:71]
  ds_read_b32 v79, v79 offset:272
  s_cmp_eq_u64 s[72:73], 0
  s_cbranch_scc1 M_SKB2
  s_mov_b64 exec, s[72:73]
  ds_read_b32 v81, v81 offset:272
  s_mov_b64 exec, s[74:75]
  ds_read_b32 v83, v83 offset:272
M_SKB2:
  s_mov_b64 exec, s[76:77]
  ds_read_b32 v85, v85 offset:272
  s_mov_b64 exec, s[78:79]
  ds_read_b32 v87, v87 offset:272
  s_cmp_eq_u64 s[80:81], 0
  s_cbranch_scc1 M_SKB3
  s_mov_b64 exec, s[80:81]
  ds_read_b32 v89, v89 offset:272
  s_mov_b64 exec, s[82:83]
  ds_read_b32 v91, v91 offset:272
M_SKB3:
  s_mov_b64 exec, -1
  v_mul_f32 v35, 0x47800000, v35
  v_cvt_u32_f32 v35, v35
  v_add_u32 v35, 1, v35
  s_lshl_b32 s43, s33, 5
  v_mad_u32_u24 v14, v14, s43, v113
  v_mul_u32_u24 v26, v2, v35
  v_lshrrev_b32 v26, 16, v26
  v_add3_u32 v27, v2, v30, -1
  v_mul_u32_u24 v27, v27, v35
  v_lshrrev_b32 v27, 16, v27
  v_add_u32 v112, v2, v30
  s_sub_u32 s44, 0, s33
  v_mad_i32_i24 v112, v27, s44, v112
  v_lshrrev_b32 v113, 2, v27
  v_cmp_eq_u32_e64 s[44:45], s30, v113
  v_cmp_lt_u32 vcc, 0, v30
  v_lshlrev_b32_e64 v112, v112, 1
  s_and_b64 s[44:45], s[44:45], vcc
  v_sub_u32 v27, v27, v26
  v_cndmask_b32_e64 v114, 0, v112, s[44:45]
  s_nop 1
  v_or_b32_dpp v114, v114, v114 row_shr:1 row_mask:0xf bank_mask:0xf bound_ctrl:0
  s_nop 1
  v_or_b32_dpp v114, v114, v114 row_shr:2 row_mask:0xf bank_mask:0xf bound_ctrl:0
  s_nop 1
  v_or_b32_dpp v114, v114, v114 row_shr:4 row_mask:0xf bank_mask:0xf bound_ctrl:0
  s_nop 1
  v_or_b32_dpp v114, v114, v114 row_shr:8 row_mask:0xf bank_mask:0xf bound_ctrl:0
  s_nop 1
  v_or_b32_dpp v114, v114, v114 row_bcast:15 row_mask:0xa bank_mask:0xf
  s_nop 1
  v_or_b32_dpp v114, v114, v114 row_bcast:31 row_mask:0xc bank_mask:0xf
  s_nop 0
  v_readlane_b32 s48, v114, 63
  v_mul_u32_u24 v33, 528, v1
  v_add_u32 v32, s30, v2
  v_cndmask_b32 v27, 0, v27, vcc
  v_lshl_or_b32 v27, v27, 8, v26
  v_subrev_u32 v30, s30, v30
  s_lshl_b32 s44, s33, 7
  s_sub_u32 s44, 4, s44
  s_mov_b32 s45, 528
  v_mov_b32 v28, 42768
  v_add_u32 v29, 21648, v33
M_DESC:
  v_cmp_lt_i32 vcc, 0, v30
  s_cbranch_vccz M_DESCD
  s_mov_b64 exec, vcc
  v_mul_u32_u24 v34, v32, v35
  v_lshrrev_b32 v34, 16, v34
  v_lshlrev_b32 v112, 7, v32
  v_mad_i32_i24 v112, v34, s44, v112
  v_cmp_eq_u32 vcc, v34, v26
  v_mad_u32_u24 v113, v34, s45, v28
  v_add_u32 v112, 77312, v112
  v_cndmask_b32 v113, v113, v29, vcc
  v_lshl_or_b32 v113, v113, 16, v33
  ds_write_b32 v112, v113
  v_add_u32 v32, 8, v32
  v_add_u32 v30, -8, v30
  s_branch M_DESC
M_DESCD:
  s_mov_b64 exec, -1
  s_cmp_lg_u32 s30, 0
  s_cbranch_scc1 M_NODEG
  v_add_u32 v3, -528, v3
  ds_add_u32 v3, v17
  ds_write_b32 v3, v27 offset:256
M_NODEG:
  s_waitcnt lgkmcnt(0)
  s_mov_b64 exec, s[52:53]
  v_lshl_add_u32 v61, v92, 2, v61
  ds_write_b32 v61, v60
  s_mov_b64 exec, s[54:55]
  v_lshl_add_u32 v63, v93, 2, v63
  ds_write_b32 v63, v62
  s_cmp_eq_u64 s[56:57], 0
  s_cbranch_scc1 M_SKC0
  s_mov_b64 exec, s[56:57]
  v_lshl_add_u32 v65, v94, 2, v65
  ds_write_b32 v65, v64
  s_mov_b64 exec, s[58:59]
  v_lshl_add_u32 v67, v95, 2, v67
  ds_write_b32 v67, v66
M_SKC0:
  s_mov_b64 exec, s[60:61]
  v_lshl_add_u32 v69, v96, 2, v69
  ds_write_b32 v69, v68
  s_mov_b64 exec, s[62:63]
  v_lshl_add_u32 v71, v97, 2, v71
  ds_write_b32 v71, v70
  s_cmp_eq_u64 s[64:65], 0
  s_cbranch_scc1 M_SKC1
  s_mov_b64 exec, s[64:65]
  v_lshl_add_u32 v73, v98, 2, v73
  ds_write_b32 v73, v72
  s_mov_b64 exec, s[66:67]
  v_lshl_add_u32 v75, v99, 2, v75
  ds_write_b32 v75, v74
M_SKC1:
  s_mov_b64 exec, s[68:69]
  v_lshl_add_u32 v77, v100, 2, v77
  ds_write_b32 v77, v76
  s_mov_b64 exec, s[70:71]
  v_lshl_add_u32 v79, v101, 2, v79
  ds_write_b32 v79, v78
  s_cmp_eq_u64 s[72:73], 0
  s_cbranch_scc1 M_SKC2
  s_mov_b64 exec, s[72:73]
  v_lshl_add_u32 v81, v102, 2, v81
  ds_write_b32 v81, v80
  s_mov_b64 exec, s[74:75]
  v_lshl_add_u32 v83, v103, 2, v83
  ds_write_b32 v83, v82
M_SKC2:
  s_mov_b64 exec, s[76:77]
  v_lshl_add_u32 v85, v104, 2, v85
  ds_write_b32 v85, v84
  s_mov_b64 exec, s[78:79]
  v_lshl_add_u32 v87, v105, 2, v87
  ds_write_b32 v87, v86
  s_cmp_eq_u64 s[80:81], 0
  s_cbranch_scc1 M_SKC3
  s_mov_b64 exec, s[80:81]
  v_lshl_add_u32 v89, v106, 2, v89
  ds_write_b32 v89, v88
  s_mov_b64 exec, s[82:83]
  v_lshl_add_u32 v91, v107, 2, v91
  ds_write_b32 v91, v90
M_SKC3:
  s_mov_b64 exec, -1
  s_mov_b32 s34, s33
  v_mov_b32 v16, 0
  v_mov_b32 v17, 0
  v_add_u32 v28, 42768, v12
  v_add_u32 v29, 42768, v12
  v_lshlrev_b32 v30, 4, v1
  v_add_u32 v30, 84736, v30
  s_waitcnt vmcnt(0) lgkmcnt(0)
  s_barrier
  s_setprio 3
  s_mov_b32 s37, 7
  ds_read_b32 v36, v14
  ds_read_b32 v40, v14 offset:32
  ds_read_b64 v[112:113], v15
  s_waitcnt lgkmcnt(2)
  v_mad_u32_u16 v5, v36, s36, v4
  buffer_load_dwordx4 a[64:67], v5, s[4:7], 0 offen offset:0
  buffer_load_dwordx4 a[68:71], v5, s[4:7], 0 offen offset:16
  buffer_load_dwordx4 a[72:75], v5, s[4:7], 0 offen offset:32
  buffer_load_dwordx4 a[76:79], v5, s[4:7], 0 offen offset:48
  s_waitcnt lgkmcnt(0)
  v_mad_u32_u16 v6, v40, s36, v4
  v_add_u32_sdwa v26, v112, v12 dst_sel:DWORD dst_unused:UNUSED_PAD src0_sel:WORD_0 src1_sel:DWORD
  v_add_u32_sdwa v27, v113, v12 dst_sel:DWORD dst_unused:UNUSED_PAD src0_sel:WORD_0 src1_sel:DWORD
  v_cmp_le_i16 vcc, 0, v36
  s_nop 1
  v_cndmask_b32 v37, 0, v10, vcc
  v_cndmask_b32 v38, 0, v11, vcc
  v_cmp_le_i16 vcc, 0, v40
  s_nop 1
  v_cndmask_b32 v41, 0, v10, vcc
  v_cndmask_b32 v42, 0, v11, vcc
  ds_read_b32 v45, v26 offset:0
  ds_read_b32 v46, v27 offset:0
  ds_read_b32 v49, v26 offset:128
  ds_read_b32 v50, v27 offset:128
  ds_read_b32 v53, v26 offset:256
  ds_read_b32 v54, v27 offset:256
  ds_read_b32 v57, v26 offset:384
  ds_read_b32 v58, v27 offset:384
  s_cmp_lg_u32 s50, 0
  s_cbranch_scc1 M_NOW
  ds_read_b128 a[0:3], v30 offset:0
  ds_read_b128 a[4:7], v30 offset:1024
  ds_read_b128 a[8:11], v30 offset:2048
  ds_read_b128 a[12:15], v30 offset:3072
  ds_read_b128 a[16:19], v30 offset:4096
  ds_read_b128 a[20:23], v30 offset:5120
  ds_read_b128 a[24:27], v30 offset:6144
  ds_read_b128 a[28:31], v30 offset:7168
  ds_read_b128 a[32:35], v30 offset:8192
  ds_read_b128 a[36:39], v30 offset:9216
  ds_read_b128 a[40:43], v30 offset:10240
  ds_read_b128 a[44:47], v30 offset:11264
  ds_read_b128 a[48:51], v30 offset:12288
  ds_read_b128 a[52:55], v30 offset:13312
  ds_read_b128 a[56:59], v30 offset:14336
  ds_read_b128 a[60:63], v30 offset:15360
  s_mov_b32 s50, 1
M_NOW:
  s_cmp_eq_u32 s34, 0
  s_cbranch_scc1 M_DONE
  s_waitcnt vmcnt(0) lgkmcnt(0)
  buffer_load_dwordx4 a[80:83], v6, s[4:7], 0 offen offset:0
  buffer_load_dwordx4 a[84:87], v6, s[4:7], 0 offen offset:16
  buffer_load_dwordx4 a[88:91], v6, s[4:7], 0 offen offset:32
  buffer_load_dwordx4 a[92:95], v6, s[4:7], 0 offen offset:48
  v_mfma_f32_32x32x16_bf16 v[60:75], v[36:39], v[44:47], 0
  v_mfma_f32_32x32x16_bf16 v[60:75], a[64:67], a[0:3], v[60:75]
  v_mfma_f32_32x32x16_bf16 v[60:75], a[68:71], a[4:7], v[60:75]
  v_mfma_f32_32x32x16_bf16 v[60:75], a[72:75], a[8:11], v[60:75]
  v_mfma_f32_32x32x16_bf16 v[60:75], a[76:79], a[12:15], v[60:75]
  s_nop 7
  s_nop 3
  s_cmp_lg_u32 s32, 0
  s_cbranch_scc1 M_LOOPS
.p2align 6
M_LOOPF:
  v_exp_f32 v92, v60
  v_mfma_f32_32x32x16_bf16 v[76:91], v[36:39], v[48:51], 0
  v_exp_f32 v93, v61
  v_exp_f32 v94, v62
  v_exp_f32 v95, v63
  v_mfma_f32_32x32x16_bf16 v[76:91], a[64:67], a[16:19], v[76:91]
  v_exp_f32 v96, v64
  v_exp_f32 v97, v65
  v_exp_f32 v98, v66
  v_mfma_f32_32x32x16_bf16 v[76:91], a[68:71], a[20:23], v[76:91]
  v_exp_f32 v99, v67
  v_exp_f32 v100, v68
  v_exp_f32 v101, v69
  v_mfma_f32_32x32x16_bf16 v[76:91], a[72:75], a[24:27], v[76:91]
  v_exp_f32 v102, v70
  v_exp_f32 v103, v71
  v_exp_f32 v104, v72
  v_mfma_f32_32x32x16_bf16 v[76:91], a[76:79], a[28:31], v[76:91]
  v_exp_f32 v105, v73
  v_exp_f32 v106, v74
  s_bitcmp1_b32 s48, 0
  v_exp_f32 v107, v75
  v_rcp_f32 v24, v20
  v_rcp_f32 v25, v21
  v_pk_fma_f32 v[16:17], v[8:9], v[20:21], v[16:17]
  v_pk_fma_f32 v[122:123], v[18:19], v[24:25], v[122:123]
  s_cbranch_scc1 M_C2_0
M_C2R_0:
  v_pk_add_f32 v[22:23], v[92:93], 1.0 op_sel_hi:[1,0]
  v_pk_fma_f32 v[18:19], v[60:61], v[94:95], v[60:61]
  ds_read_b64 v[114:115], v15 offset:128
  v_pk_fma_f32 v[8:9], v[22:23], v[94:95], v[22:23]
  v_pk_fma_f32 v[18:19], v[62:63], v[22:23], v[18:19]
  v_pk_fma_f32 v[22:23], v[64:65], v[8:9], v[18:19]
  v_pk_fma_f32 v[8:9], v[8:9], v[96:97], v[8:9]
  v_pk_fma_f32 v[18:19], v[18:19], v[96:97], v[22:23]
  v_pk_fma_f32 v[22:23], v[66:67], v[8:9], v[18:19]
  v_pk_fma_f32 v[8:9], v[8:9], v[98:99], v[8:9]
  v_pk_fma_f32 v[18:19], v[18:19], v[98:99], v[22:23]
  v_pk_fma_f32 v[22:23], v[68:69], v[8:9], v[18:19]
  v_pk_fma_f32 v[8:9], v[8:9], v[100:101], v[8:9]
  v_pk_fma_f32 v[18:19], v[18:19], v[100:101], v[22:23]
  v_pk_fma_f32 v[22:23], v[70:71], v[8:9], v[18:19]
  v_pk_fma_f32 v[8:9], v[8:9], v[102:103], v[8:9]
  v_pk_fma_f32 v[18:19], v[18:19], v[102:103], v[22:23]
  v_pk_fma_f32 v[22:23], v[72:73], v[8:9], v[18:19]
  v_pk_fma_f32 v[8:9], v[8:9], v[104:105], v[8:9]
  v_pk_fma_f32 v[18:19], v[18:19], v[104:105], v[22:23]
  v_pk_fma_f32 v[22:23], v[74:75], v[8:9], v[18:19]
  v_pk_fma_f32 v[8:9], v[8:9], v[106:107], v[8:9]
  v_pk_fma_f32 v[18:19], v[18:19], v[106:107], v[22:23]
  v_exp_f32 v92, v76
  v_mfma_f32_32x32x16_bf16 v[60:75], v[36:39], v[52:55], 0
  v_exp_f32 v93, v77
  v_exp_f32 v94, v78
  s_cmp_eq_u32 s34, s37
  v_exp_f32 v95, v79
  v_mfma_f32_32x32x16_bf16 v[60:75], a[64:67], a[32:35], v[60:75]
  v_exp_f32 v96, v80
  s_cbranch_scc1 M_PR_0
M_PRR_0:
  v_exp_f32 v97, v81
  v_exp_f32 v98, v82
  v_mfma_f32_32x32x16_bf16 v[60:75], a[68:71], a[36:39], v[60:75]
  v_exp_f32 v99, v83
  v_exp_f32 v100, v84
  v_exp_f32 v101, v85
  v_mfma_f32_32x32x16_bf16 v[60:75], a[72:75], a[40:43], v[60:75]
  v_exp_f32 v102, v86
  v_exp_f32 v103, v87
  v_exp_f32 v104, v88
  v_mfma_f32_32x32x16_bf16 v[60:75], a[76:79], a[44:47], v[60:75]
  v_exp_f32 v105, v89
  v_exp_f32 v106, v90
  v_exp_f32 v107, v91
  v_rcp_f32 v24, v8
  v_rcp_f32 v25, v9
  v_pk_add_f32 v[22:23], v[92:93], 1.0 op_sel_hi:[1,0]
  v_pk_fma_f32 v[116:117], v[18:19], v[24:25], v[116:117]
  v_pk_fma_f32 v[18:19], v[76:77], v[94:95], v[76:77]
  v_pk_fma_f32 v[20:21], v[22:23], v[94:95], v[22:23]
  v_pk_fma_f32 v[18:19], v[78:79], v[22:23], v[18:19]
  v_pk_fma_f32 v[22:23], v[80:81], v[20:21], v[18:19]
  v_pk_fma_f32 v[20:21], v[20:21], v[96:97], v[20:21]
  v_pk_fma_f32 v[18:19], v[18:19], v[96:97], v[22:23]
  v_pk_fma_f32 v[22:23], v[82:83], v[20:21], v[18:19]
  v_pk_fma_f32 v[20:21], v[20:21], v[98:99], v[20:21]
  v_pk_fma_f32 v[18:19], v[18:19], v[98:99], v[22:23]
  v_pk_fma_f32 v[22:23], v[84:85], v[20:21], v[18:19]
  v_pk_fma_f32 v[20:21], v[20:21], v[100:101], v[20:21]
  v_pk_fma_f32 v[18:19], v[18:19], v[100:101], v[22:23]
  v_pk_fma_f32 v[22:23], v[86:87], v[20:21], v[18:19]
  v_pk_fma_f32 v[20:21], v[20:21], v[102:103], v[20:21]
  v_pk_fma_f32 v[18:19], v[18:19], v[102:103], v[22:23]
  v_pk_fma_f32 v[22:23], v[88:89], v[20:21], v[18:19]
  v_pk_fma_f32 v[20:21], v[20:21], v[104:105], v[20:21]
  v_pk_fma_f32 v[18:19], v[18:19], v[104:105], v[22:23]
  v_pk_fma_f32 v[22:23], v[90:91], v[20:21], v[18:19]
  v_pk_fma_f32 v[20:21], v[20:21], v[106:107], v[20:21]
  v_pk_fma_f32 v[18:19], v[18:19], v[106:107], v[22:23]
  v_exp_f32 v92, v60
  v_mfma_f32_32x32x16_bf16 v[76:91], v[36:39], v[56:59], 0
  s_bitcmp1_b32 s48, 1
  v_exp_f32 v93, v61
  s_waitcnt lgkmcnt(0)
  s_cbranch_scc1 M_C1_0
M_C1R_0:
  v_exp_f32 v94, v62
  v_exp_f32 v95, v63
  v_mfma_f32_32x32x16_bf16 v[76:91], a[64:67], a[48:51], v[76:91]
  v_exp_f32 v96, v64
  v_exp_f32 v97, v65
  v_exp_f32 v98, v66
  v_mfma_f32_32x32x16_bf16 v[76:91], a[68:71], a[52:55], v[76:91]
  v_exp_f32 v99, v67
  v_exp_f32 v100, v68
  v_exp_f32 v101, v69
  v_mfma_f32_32x32x16_bf16 v[76:91], a[72:75], a[56:59], v[76:91]
  v_exp_f32 v102, v70
  v_exp_f32 v103, v71
  v_exp_f32 v104, v72
  v_mfma_f32_32x32x16_bf16 v[76:91], a[76:79], a[60:63], v[76:91]
  v_exp_f32 v105, v73
  v_exp_f32 v106, v74
  v_exp_f32 v107, v75
  v_rcp_f32 v24, v20
  v_rcp_f32 v25, v21
  v_pk_fma_f32 v[16:17], v[8:9], v[20:21], v[16:17]
  v_pk_fma_f32 v[118:119], v[18:19], v[24:25], v[118:119]
  v_pk_add_f32 v[22:23], v[92:93], 1.0 op_sel_hi:[1,0]
  v_pk_fma_f32 v[18:19], v[60:61], v[94:95], v[60:61]
  ds_read_b32 v36, v14 offset:64
  v_pk_fma_f32 v[8:9], v[22:23], v[94:95], v[22:23]
  v_pk_fma_f32 v[18:19], v[62:63], v[22:23], v[18:19]
  s_lshr_b32 s48, s48, 1
  v_pk_fma_f32 v[22:23], v[64:65], v[8:9], v[18:19]
  s_sub_u32 s34, s34, 1
  v_pk_fma_f32 v[8:9], v[8:9], v[96:97], v[8:9]
  v_pk_fma_f32 v[18:19], v[18:19], v[96:97], v[22:23]
  v_pk_fma_f32 v[22:23], v[66:67], v[8:9], v[18:19]
  v_pk_fma_f32 v[8:9], v[8:9], v[98:99], v[8:9]
  v_pk_fma_f32 v[18:19], v[18:19], v[98:99], v[22:23]
  v_pk_fma_f32 v[22:23], v[68:69], v[8:9], v[18:19]
  v_pk_fma_f32 v[8:9], v[8:9], v[100:101], v[8:9]
  v_pk_fma_f32 v[18:19], v[18:19], v[100:101], v[22:23]
  v_pk_fma_f32 v[22:23], v[70:71], v[8:9], v[18:19]
  v_pk_fma_f32 v[8:9], v[8:9], v[102:103], v[8:9]
  v_pk_fma_f32 v[18:19], v[18:19], v[102:103], v[22:23]
  v_pk_fma_f32 v[22:23], v[72:73], v[8:9], v[18:19]
  v_pk_fma_f32 v[8:9], v[8:9], v[104:105], v[8:9]
  v_pk_fma_f32 v[18:19], v[18:19], v[104:105], v[22:23]
  v_pk_fma_f32 v[22:23], v[74:75], v[8:9], v[18:19]
  v_pk_fma_f32 v[8:9], v[8:9], v[106:107], v[8:9]
  v_pk_fma_f32 v[18:19], v[18:19], v[106:107], v[22:23]
  v_exp_f32 v92, v76
  s_waitcnt lgkmcnt(7)
  v_mfma_f32_32x32x16_bf16 v[60:75], v[40:43], v[44:47], 0
  v_exp_f32 v93, v77
  v_exp_f32 v94, v78
  v_exp_f32 v95, v79
  s_waitcnt vmcnt(0)
  v_mfma_f32_32x32x16_bf16 v[60:75], a[80:83], a[0:3], v[60:75]
  v_exp_f32 v96, v80
  v_exp_f32 v97, v81
  v_exp_f32 v98, v82
  v_mfma_f32_32x32x16_bf16 v[60:75], a[84:87], a[4:7], v[60:75]
  v_exp_f32 v99, v83
  v_exp_f32 v100, v84
  v_exp_f32 v101, v85
  v_mfma_f32_32x32x16_bf16 v[60:75], a[88:91], a[8:11], v[60:75]
  v_exp_f32 v102, v86
  v_exp_f32 v103, v87
  v_exp_f32 v104, v88
  v_mfma_f32_32x32x16_bf16 v[60:75], a[92:95], a[12:15], v[60:75]
  v_exp_f32 v105, v89
  v_exp_f32 v106, v90
  v_exp_f32 v107, v91
  v_rcp_f32 v24, v8
  v_rcp_f32 v25, v9
  v_pk_add_f32 v[22:23], v[92:93], 1.0 op_sel_hi:[1,0]
  s_waitcnt lgkmcnt(0)
  v_mad_u32_u16 v5, v36, s36, v4
  v_pk_fma_f32 v[120:121], v[18:19], v[24:25], v[120:121]
  v_pk_fma_f32 v[18:19], v[76:77], v[94:95], v[76:77]
  v_pk_fma_f32 v[20:21], v[22:23], v[94:95], v[22:23]
  v_pk_fma_f32 v[18:19], v[78:79], v[22:23], v[18:19]
  v_cmp_le_i16 vcc, 0, v36
  v_pk_fma_f32 v[22:23], v[80:81], v[20:21], v[18:19]
  v_pk_fma_f32 v[20:21], v[20:21], v[96:97], v[20:21]
  v_pk_fma_f32 v[18:19], v[18:19], v[96:97], v[22:23]
  v_cndmask_b32 v37, 0, v10, vcc
  v_pk_fma_f32 v[22:23], v[82:83], v[20:21], v[18:19]
  v_cndmask_b32 v38, 0, v11, vcc
  v_pk_fma_f32 v[20:21], v[20:21], v[98:99], v[20:21]
  v_pk_fma_f32 v[18:19], v[18:19], v[98:99], v[22:23]
  s_cmp_eq_u32 s34, 0
  v_pk_fma_f32 v[22:23], v[84:85], v[20:21], v[18:19]
  v_pk_fma_f32 v[20:21], v[20:21], v[100:101], v[20:21]
  v_pk_fma_f32 v[18:19], v[18:19], v[100:101], v[22:23]
  v_pk_fma_f32 v[22:23], v[86:87], v[20:21], v[18:19]
  v_pk_fma_f32 v[20:21], v[20:21], v[102:103], v[20:21]
  v_pk_fma_f32 v[18:19], v[18:19], v[102:103], v[22:23]
  v_pk_fma_f32 v[22:23], v[88:89], v[20:21], v[18:19]
  v_pk_fma_f32 v[20:21], v[20:21], v[104:105], v[20:21]
  buffer_load_dwordx4 a[64:67], v5, s[4:7], 0 offen offset:0
  buffer_load_dwordx4 a[68:71], v5, s[4:7], 0 offen offset:16
  buffer_load_dwordx4 a[72:75], v5, s[4:7], 0 offen offset:32
  buffer_load_dwordx4 a[76:79], v5, s[4:7], 0 offen offset:48
  v_pk_fma_f32 v[18:19], v[18:19], v[104:105], v[22:23]
  v_pk_fma_f32 v[22:23], v[90:91], v[20:21], v[18:19]
  v_pk_fma_f32 v[20:21], v[20:21], v[106:107], v[20:21]
  v_pk_fma_f32 v[18:19], v[18:19], v[106:107], v[22:23]
  s_cbranch_scc1 M_FFIN0
  v_exp_f32 v92, v60
  v_mfma_f32_32x32x16_bf16 v[76:91], v[40:43], v[48:51], 0
  v_exp_f32 v93, v61
  v_exp_f32 v94, v62
  v_exp_f32 v95, v63
  v_mfma_f32_32x32x16_bf16 v[76:91], a[80:83], a[16:19], v[76:91]
  v_exp_f32 v96, v64
  v_exp_f32 v97, v65
  v_exp_f32 v98, v66
  v_mfma_f32_32x32x16_bf16 v[76:91], a[84:87], a[20:23], v[76:91]
  v_exp_f32 v99, v67
  v_exp_f32 v100, v68
  v_exp_f32 v101, v69
  v_mfma_f32_32x32x16_bf16 v[76:91], a[88:91], a[24:27], v[76:91]
  v_exp_f32 v102, v70
  v_exp_f32 v103, v71
  v_exp_f32 v104, v72
  v_mfma_f32_32x32x16_bf16 v[76:91], a[92:95], a[28:31], v[76:91]
  v_exp_f32 v105, v73
  v_exp_f32 v106, v74
  s_bitcmp1_b32 s48, 0
  v_exp_f32 v107, v75
  v_rcp_f32 v24, v20
  v_rcp_f32 v25, v21
  v_pk_fma_f32 v[16:17], v[8:9], v[20:21], v[16:17]
  v_pk_fma_f32 v[122:123], v[18:19], v[24:25], v[122:123]
  s_cbranch_scc1 M_C2_1
M_C2R_1:
  v_pk_add_f32 v[22:23], v[92:93], 1.0 op_sel_hi:[1,0]
  v_pk_fma_f32 v[18:19], v[60:61], v[94:95], v[60:61]
  ds_read_b64 v[112:113], v15 offset:256
  v_pk_fma_f32 v[8:9], v[22:23], v[94:95], v[22:23]
  v_pk_fma_f32 v[18:19], v[62:63], v[22:23], v[18:19]
  v_pk_fma_f32 v[22:23], v[64:65], v[8:9], v[18:19]
  v_pk_fma_f32 v[8:9], v[8:9], v[96:97], v[8:9]
  v_pk_fma_f32 v[18:19], v[18:19], v[96:97], v[22:23]
  v_pk_fma_f32 v[22:23], v[66:67], v[8:9], v[18:19]
  v_pk_fma_f32 v[8:9], v[8:9], v[98:99], v[8:9]
  v_pk_fma_f32 v[18:19], v[18:19], v[98:99], v[22:23]
  v_pk_fma_f32 v[22:23], v[68:69], v[8:9], v[18:19]
  v_pk_fma_f32 v[8:9], v[8:9], v[100:101], v[8:9]
  v_pk_fma_f32 v[18:19], v[18:19], v[100:101], v[22:23]
  v_pk_fma_f32 v[22:23], v[70:71], v[8:9], v[18:19]
  v_pk_fma_f32 v[8:9], v[8:9], v[102:103], v[8:9]
  v_pk_fma_f32 v[18:19], v[18:19], v[102:103], v[22:23]
  v_pk_fma_f32 v[22:23], v[72:73], v[8:9], v[18:19]
  v_pk_fma_f32 v[8:9], v[8:9], v[104:105], v[8:9]
  v_pk_fma_f32 v[18:19], v[18:19], v[104:105], v[22:23]
  v_pk_fma_f32 v[22:23], v[74:75], v[8:9], v[18:19]
  v_pk_fma_f32 v[8:9], v[8:9], v[106:107], v[8:9]
  v_pk_fma_f32 v[18:19], v[18:19], v[106:107], v[22:23]
  v_exp_f32 v92, v76
  v_mfma_f32_32x32x16_bf16 v[60:75], v[40:43], v[52:55], 0
  v_exp_f32 v93, v77
  v_exp_f32 v94, v78
  s_cmp_eq_u32 s34, s37
  v_exp_f32 v95, v79
  v_mfma_f32_32x32x16_bf16 v[60:75], a[80:83], a[32:35], v[60:75]
  v_exp_f32 v96, v80
  s_cbranch_scc1 M_PR_1
M_PRR_1:
  v_exp_f32 v97, v81
  v_exp_f32 v98, v82
  v_mfma_f32_32x32x16_bf16 v[60:75], a[84:87], a[36:39], v[60:75]
  v_exp_f32 v99, v83
  v_exp_f32 v100, v84
  v_exp_f32 v101, v85
  v_mfma_f32_32x32x16_bf16 v[60:75], a[88:91], a[40:43], v[60:75]
  v_exp_f32 v102, v86
  v_exp_f32 v103, v87
  v_exp_f32 v104, v88
  v_mfma_f32_32x32x16_bf16 v[60:75], a[92:95], a[44:47], v[60:75]
  v_exp_f32 v105, v89
  v_exp_f32 v106, v90
  v_exp_f32 v107, v91
  v_rcp_f32 v24, v8
  v_rcp_f32 v25, v9
  v_pk_add_f32 v[22:23], v[92:93], 1.0 op_sel_hi:[1,0]
  v_pk_fma_f32 v[116:117], v[18:19], v[24:25], v[116:117]
  v_pk_fma_f32 v[18:19], v[76:77], v[94:95], v[76:77]
  v_pk_fma_f32 v[20:21], v[22:23], v[94:95], v[22:23]
  v_pk_fma_f32 v[18:19], v[78:79], v[22:23], v[18:19]
  v_pk_fma_f32 v[22:23], v[80:81], v[20:21], v[18:19]
  v_pk_fma_f32 v[20:21], v[20:21], v[96:97], v[20:21]
  v_pk_fma_f32 v[18:19], v[18:19], v[96:97], v[22:23]
  v_pk_fma_f32 v[22:23], v[82:83], v[20:21], v[18:19]
  v_pk_fma_f32 v[20:21], v[20:21], v[98:99], v[20:21]
  v_pk_fma_f32 v[18:19], v[18:19], v[98:99], v[22:23]
  v_pk_fma_f32 v[22:23], v[84:85], v[20:21], v[18:19]
  v_pk_fma_f32 v[20:21], v[20:21], v[100:101], v[20:21]
  v_pk_fma_f32 v[18:19], v[18:19], v[100:101], v[22:23]
  v_pk_fma_f32 v[22:23], v[86:87], v[20:21], v[18:19]
  v_pk_fma_f32 v[20:21], v[20:21], v[102:103], v[20:21]
  v_pk_fma_f32 v[18:19], v[18:19], v[102:103], v[22:23]
  v_pk_fma_f32 v[22:23], v[88:89], v[20:21], v[18:19]
  v_pk_fma_f32 v[20:21], v[20:21], v[104:105], v[20:21]
  v_pk_fma_f32 v[18:19], v[18:19], v[104:105], v[22:23]
  v_pk_fma_f32 v[22:23], v[90:91], v[20:21], v[18:19]
  v_pk_fma_f32 v[20:21], v[20:21], v[106:107], v[20:21]
  v_pk_fma_f32 v[18:19], v[18:19], v[106:107], v[22:23]
  v_exp_f32 v92, v60
  v_mfma_f32_32x32x16_bf16 v[76:91], v[40:43], v[56:59], 0
  s_bitcmp1_b32 s48, 1
  v_exp_f32 v93, v61
  s_waitcnt lgkmcnt(0)
  s_cbranch_scc1 M_C1_1
M_C1R_1:
  v_exp_f32 v94, v62
  v_exp_f32 v95, v63
  v_mfma_f32_32x32x16_bf16 v[76:91], a[80:83], a[48:51], v[76:91]
  v_exp_f32 v96, v64
  v_exp_f32 v97, v65
  v_exp_f32 v98, v66
  v_mfma_f32_32x32x16_bf16 v[76:91], a[84:87], a[52:55], v[76:91]
  v_exp_f32 v99, v67
  v_exp_f32 v100, v68
  v_exp_f32 v101, v69
  v_mfma_f32_32x32x16_bf16 v[76:91], a[88:91], a[56:59], v[76:91]
  v_exp_f32 v102, v70
  v_exp_f32 v103, v71
  v_exp_f32 v104, v72
  v_mfma_f32_32x32x16_bf16 v[76:91], a[92:95], a[60:63], v[76:91]
  v_exp_f32 v105, v73
  v_exp_f32 v106, v74
  v_exp_f32 v107, v75
  v_rcp_f32 v24, v20
  v_rcp_f32 v25, v21
  v_pk_fma_f32 v[16:17], v[8:9], v[20:21], v[16:17]
  v_pk_fma_f32 v[118:119], v[18:19], v[24:25], v[118:119]
  v_pk_add_f32 v[22:23], v[92:93], 1.0 op_sel_hi:[1,0]
  v_pk_fma_f32 v[18:19], v[60:61], v[94:95], v[60:61]
  ds_read_b32 v40, v14 offset:96
  v_pk_fma_f32 v[8:9], v[22:23], v[94:95], v[22:23]
  v_pk_fma_f32 v[18:19], v[62:63], v[22:23], v[18:19]
  s_lshr_b32 s48, s48, 1
  v_pk_fma_f32 v[22:23], v[64:65], v[8:9], v[18:19]
  s_sub_u32 s34, s34, 1
  v_pk_fma_f32 v[8:9], v[8:9], v[96:97], v[8:9]
  v_pk_fma_f32 v[18:19], v[18:19], v[96:97], v[22:23]
  v_add_u32 v14, 64, v14
  v_pk_fma_f32 v[22:23], v[66:67], v[8:9], v[18:19]
  v_add_u32 v15, 256, v15
  v_pk_fma_f32 v[8:9], v[8:9], v[98:99], v[8:9]
  v_pk_fma_f32 v[18:19], v[18:19], v[98:99], v[22:23]
  v_pk_fma_f32 v[22:23], v[68:69], v[8:9], v[18:19]
  v_pk_fma_f32 v[8:9], v[8:9], v[100:101], v[8:9]
  v_pk_fma_f32 v[18:19], v[18:19], v[100:101], v[22:23]
  v_pk_fma_f32 v[22:23], v[70:71], v[8:9], v[18:19]
  v_pk_fma_f32 v[8:9], v[8:9], v[102:103], v[8:9]
  v_pk_fma_f32 v[18:19], v[18:19], v[102:103], v[22:23]
  v_pk_fma_f32 v[22:23], v[72:73], v[8:9], v[18:19]
  v_pk_fma_f32 v[8:9], v[8:9], v[104:105], v[8:9]
  v_pk_fma_f32 v[18:19], v[18:19], v[104:105], v[22:23]
  v_pk_fma_f32 v[22:23], v[74:75], v[8:9], v[18:19]
  v_pk_fma_f32 v[8:9], v[8:9], v[106:107], v[8:9]
  v_pk_fma_f32 v[18:19], v[18:19], v[106:107], v[22:23]
  v_exp_f32 v92, v76
  s_waitcnt lgkmcnt(7)
  v_mfma_f32_32x32x16_bf16 v[60:75], v[36:39], v[44:47], 0
  v_exp_f32 v93, v77
  v_exp_f32 v94, v78
  v_exp_f32 v95, v79
  s_waitcnt vmcnt(0)
  v_mfma_f32_32x32x16_bf16 v[60:75], a[64:67], a[0:3], v[60:75]
  v_exp_f32 v96, v80
  v_exp_f32 v97, v81
  v_exp_f32 v98, v82
  v_mfma_f32_32x32x16_bf16 v[60:75], a[68:71], a[4:7], v[60:75]
  v_exp_f32 v99, v83
  v_exp_f32 v100, v84
  v_exp_f32 v101, v85
  v_mfma_f32_32x32x16_bf16 v[60:75], a[72:75], a[8:11], v[60:75]
  v_exp_f32 v102, v86
  v_exp_f32 v103, v87
  v_exp_f32 v104, v88
  v_mfma_f32_32x32x16_bf16 v[60:75], a[76:79], a[12:15], v[60:75]
  v_exp_f32 v105, v89
  v_exp_f32 v106, v90
  v_exp_f32 v107, v91
  v_rcp_f32 v24, v8
  v_rcp_f32 v25, v9
  v_pk_add_f32 v[22:23], v[92:93], 1.0 op_sel_hi:[1,0]
  s_waitcnt lgkmcnt(0)
  v_mad_u32_u16 v5, v40, s36, v4
  v_pk_fma_f32 v[120:121], v[18:19], v[24:25], v[120:121]
  v_pk_fma_f32 v[18:19], v[76:77], v[94:95], v[76:77]
  v_pk_fma_f32 v[20:21], v[22:23], v[94:95], v[22:23]
  v_pk_fma_f32 v[18:19], v[78:79], v[22:23], v[18:19]
  v_cmp_le_i16 vcc, 0, v40
  v_pk_fma_f32 v[22:23], v[80:81], v[20:21], v[18:19]
  v_pk_fma_f32 v[20:21], v[20:21], v[96:97], v[20:21]
  v_pk_fma_f32 v[18:19], v[18:19], v[96:97], v[22:23]
  v_cndmask_b32 v41, 0, v10, vcc
  v_pk_fma_f32 v[22:23], v[82:83], v[20:21], v[18:19]
  v_cndmask_b32 v42, 0, v11, vcc
  v_pk_fma_f32 v[20:21], v[20:21], v[98:99], v[20:21]
  v_pk_fma_f32 v[18:19], v[18:19], v[98:99], v[22:23]
  s_cmp_eq_u32 s34, 0
  v_pk_fma_f32 v[22:23], v[84:85], v[20:21], v[18:19]
  v_pk_fma_f32 v[20:21], v[20:21], v[100:101], v[20:21]
  v_pk_fma_f32 v[18:19], v[18:19], v[100:101], v[22:23]
  v_pk_fma_f32 v[22:23], v[86:87], v[20:21], v[18:19]
  v_pk_fma_f32 v[20:21], v[20:21], v[102:103], v[20:21]
  v_pk_fma_f32 v[18:19], v[18:19], v[102:103], v[22:23]
  v_pk_fma_f32 v[22:23], v[88:89], v[20:21], v[18:19]
  v_pk_fma_f32 v[20:21], v[20:21], v[104:105], v[20:21]
  buffer_load_dwordx4 a[80:83], v5, s[4:7], 0 offen offset:0
  buffer_load_dwordx4 a[84:87], v5, s[4:7], 0 offen offset:16
  buffer_load_dwordx4 a[88:91], v5, s[4:7], 0 offen offset:32
  buffer_load_dwordx4 a[92:95], v5, s[4:7], 0 offen offset:48
  v_pk_fma_f32 v[18:19], v[18:19], v[104:105], v[22:23]
  v_pk_fma_f32 v[22:23], v[90:91], v[20:21], v[18:19]
  v_pk_fma_f32 v[20:21], v[20:21], v[106:107], v[20:21]
  v_pk_fma_f32 v[18:19], v[18:19], v[106:107], v[22:23]
  s_cbranch_scc0 M_LOOPF
  v_rcp_f32 v24, v20
  v_rcp_f32 v25, v21
  v_pk_fma_f32 v[16:17], v[8:9], v[20:21], v[16:17]
  v_pk_fma_f32 v[122:123], v[18:19], v[24:25], v[122:123]
  v_add_u32_sdwa v28, v114, v12 dst_sel:DWORD dst_unused:UNUSED_PAD src0_sel:WORD_1 src1_sel:DWORD
  v_add_u32_sdwa v29, v115, v12 dst_sel:DWORD dst_unused:UNUSED_PAD src0_sel:WORD_1 src1_sel:DWORD
  ds_write2_b32 v28, v116, v118 offset0:0 offset1:32
  ds_write2_b32 v29, v117, v119 offset0:0 offset1:32
  ds_write2_b32 v28, v120, v122 offset0:64 offset1:96
  ds_write2_b32 v29, v121, v123 offset0:64 offset1:96
  v_pk_fma_f32 v[16:17], v[116:117], 0, v[16:17] op_sel_hi:[1,0,1]
  v_pk_fma_f32 v[16:17], v[118:119], 0, v[16:17] op_sel_hi:[1,0,1]
  v_pk_fma_f32 v[16:17], v[120:121], 0, v[16:17] op_sel_hi:[1,0,1]
  v_pk_fma_f32 v[16:17], v[122:123], 0, v[16:17] op_sel_hi:[1,0,1]
  s_branch M_DONE
M_FFIN0:
  v_rcp_f32 v24, v20
  v_rcp_f32 v25, v21
  v_pk_fma_f32 v[16:17], v[8:9], v[20:21], v[16:17]
  v_pk_fma_f32 v[122:123], v[18:19], v[24:25], v[122:123]
  v_add_u32_sdwa v28, v112, v12 dst_sel:DWORD dst_unused:UNUSED_PAD src0_sel:WORD_1 src1_sel:DWORD
  v_add_u32_sdwa v29, v113, v12 dst_sel:DWORD dst_unused:UNUSED_PAD src0_sel:WORD_1 src1_sel:DWORD
  ds_write2_b32 v28, v116, v118 offset0:0 offset1:32
  ds_write2_b32 v29, v117, v119 offset0:0 offset1:32
  ds_write2_b32 v28, v120, v122 offset0:64 offset1:96
  ds_write2_b32 v29, v121, v123 offset0:64 offset1:96
  v_pk_fma_f32 v[16:17], v[116:117], 0, v[16:17] op_sel_hi:[1,0,1]
  v_pk_fma_f32 v[16:17], v[118:119], 0, v[16:17] op_sel_hi:[1,0,1]
  v_pk_fma_f32 v[16:17], v[120:121], 0, v[16:17] op_sel_hi:[1,0,1]
  v_pk_fma_f32 v[16:17], v[122:123], 0, v[16:17] op_sel_hi:[1,0,1]
  s_branch M_DONE
M_C2_0:
  v_cmp_eq_u32 vcc, v114, v112
  v_cmp_eq_u32_e64 s[40:41], v115, v113
  v_add_u32_sdwa v28, v114, v12 dst_sel:DWORD dst_unused:UNUSED_PAD src0_sel:WORD_1 src1_sel:DWORD
  v_add_u32_sdwa v29, v115, v12 dst_sel:DWORD dst_unused:UNUSED_PAD src0_sel:WORD_1 src1_sel:DWORD
  ds_write2_b32 v28, v116, v118 offset0:0 offset1:32
  ds_write2_b32 v29, v117, v119 offset0:0 offset1:32
  ds_write2_b32 v28, v120, v122 offset0:64 offset1:96
  ds_write2_b32 v29, v121, v123 offset0:64 offset1:96
  v_cndmask_b32_e64 v32, 0, 1.0, vcc
  v_cndmask_b32_e64 v33, 0, 1.0, s[40:41]
  v_pk_mul_f32 v[116:117], v[116:117], v[32:33]
  v_pk_mul_f32 v[118:119], v[118:119], v[32:33]
  v_pk_mul_f32 v[120:121], v[120:121], v[32:33]
  v_pk_mul_f32 v[122:123], v[122:123], v[32:33]
  s_branch M_C2R_0
M_PR_0:
  s_setprio 0
  s_cmp_eq_u32 s37, 2
  s_cbranch_scc1 M_PRR_0
  s_setprio 1
  s_cmp_eq_u32 s37, 4
  s_mov_b32 s37, 2
  s_cbranch_scc1 M_PRR_0
  s_setprio 2
  s_mov_b32 s37, 4
  v_lshlrev_b32 v28, 4, v1
  v_lshrrev_b32 v29, 4, v1
  s_and_b32 s40, s30, 1
  v_lshlrev_b32 v29, 3, v29
  s_lshl_b32 s45, s40, 6
  s_add_u32 s45, s45, 5817856
  s_lshl_b32 s40, s40, 13
  s_add_u32 s40, s40, 5799936
  s_add_u32 s41, s40, 4096
  buffer_load_dwordx4 a[96:99], v28, s[8:11], s40 offen offset:0
  buffer_load_dwordx4 a[100:103], v28, s[8:11], s40 offen offset:1024
  buffer_load_dwordx4 a[104:107], v28, s[8:11], s40 offen offset:2048
  buffer_load_dwordx4 a[108:111], v28, s[8:11], s40 offen offset:3072
  buffer_load_dwordx4 a[112:115], v28, s[8:11], s41 offen offset:0
  buffer_load_dwordx4 a[116:119], v28, s[8:11], s41 offen offset:1024
  buffer_load_dwordx4 a[120:123], v28, s[8:11], s41 offen offset:2048
  buffer_load_dwordx4 a[124:127], v28, s[8:11], s41 offen offset:3072
  buffer_load_dwordx2 v[108:109], v29, s[8:11], s45 offen offset:0
  buffer_load_dwordx2 v[110:111], v29, s[8:11], s45 offen offset:32
  s_mov_b32 s49, 1
  s_branch M_PRR_0
M_C1_0:
  v_add_u32_sdwa v26, v114, v12 dst_sel:DWORD dst_unused:UNUSED_PAD src0_sel:WORD_0 src1_sel:DWORD
  v_add_u32_sdwa v27, v115, v12 dst_sel:DWORD dst_unused:UNUSED_PAD src0_sel:WORD_0 src1_sel:DWORD
  ds_read_b32 v45, v26 offset:0
  ds_read_b32 v46, v27 offset:0
  ds_read_b32 v49, v26 offset:128
  ds_read_b32 v50, v27 offset:128
  ds_read_b32 v53, v26 offset:256
  ds_read_b32 v54, v27 offset:256
  ds_read_b32 v57, v26 offset:384
  ds_read_b32 v58, v27 offset:384
  s_branch M_C1R_0
M_C2_1:
  v_cmp_eq_u32 vcc, v112, v114
  v_cmp_eq_u32_e64 s[40:41], v113, v115
  v_add_u32_sdwa v28, v112, v12 dst_sel:DWORD dst_unused:UNUSED_PAD src0_sel:WORD_1 src1_sel:DWORD
  v_add_u32_sdwa v29, v113, v12 dst_sel:DWORD dst_unused:UNUSED_PAD src0_sel:WORD_1 src1_sel:DWORD
  ds_write2_b32 v28, v116, v118 offset0:0 offset1:32
  ds_write2_b32 v29, v117, v119 offset0:0 offset1:32
  ds_write2_b32 v28, v120, v122 offset0:64 offset1:96
  ds_write2_b32 v29, v121, v123 offset0:64 offset1:96
  v_cndmask_b32_e64 v32, 0, 1.0, vcc
  v_cndmask_b32_e64 v33, 0, 1.0, s[40:41]
  v_pk_mul_f32 v[116:117], v[116:117], v[32:33]
  v_pk_mul_f32 v[118:119], v[118:119], v[32:33]
  v_pk_mul_f32 v[120:121], v[120:121], v[32:33]
  v_pk_mul_f32 v[122:123], v[122:123], v[32:33]
  s_branch M_C2R_1
M_PR_1:
  s_setprio 0
  s_cmp_eq_u32 s37, 2
  s_cbranch_scc1 M_PRR_1
  s_setprio 1
  s_cmp_eq_u32 s37, 4
  s_mov_b32 s37, 2
  s_cbranch_scc1 M_PRR_1
  s_setprio 2
  s_mov_b32 s37, 4
  v_lshlrev_b32 v28, 4, v1
  v_lshrrev_b32 v29, 4, v1
  s_and_b32 s40, s30, 1
  v_lshlrev_b32 v29, 3, v29
  s_lshl_b32 s45, s40, 6
  s_add_u32 s45, s45, 5817856
  s_lshl_b32 s40, s40, 13
  s_add_u32 s40, s40, 5799936
  s_add_u32 s41, s40, 4096
  buffer_load_dwordx4 a[96:99], v28, s[8:11], s40 offen offset:0
  buffer_load_dwordx4 a[100:103], v28, s[8:11], s40 offen offset:1024
  buffer_load_dwordx4 a[104:107], v28, s[8:11], s40 offen offset:2048
  buffer_load_dwordx4 a[108:111], v28, s[8:11], s40 offen offset:3072
  buffer_load_dwordx4 a[112:115], v28, s[8:11], s41 offen offset:0
  buffer_load_dwordx4 a[116:119], v28, s[8:11], s41 offen offset:1024
  buffer_load_dwordx4 a[120:123], v28, s[8:11], s41 offen offset:2048
  buffer_load_dwordx4 a[124:127], v28, s[8:11], s41 offen offset:3072
  buffer_load_dwordx2 v[108:109], v29, s[8:11], s45 offen offset:0
  buffer_load_dwordx2 v[110:111], v29, s[8:11], s45 offen offset:32
  s_mov_b32 s49, 1
  s_branch M_PRR_1
M_C1_1:
  v_add_u32_sdwa v26, v112, v12 dst_sel:DWORD dst_unused:UNUSED_PAD src0_sel:WORD_0 src1_sel:DWORD
  v_add_u32_sdwa v27, v113, v12 dst_sel:DWORD dst_unused:UNUSED_PAD src0_sel:WORD_0 src1_sel:DWORD
  ds_read_b32 v45, v26 offset:0
  ds_read_b32 v46, v27 offset:0
  ds_read_b32 v49, v26 offset:128
  ds_read_b32 v50, v27 offset:128
  ds_read_b32 v53, v26 offset:256
  ds_read_b32 v54, v27 offset:256
  ds_read_b32 v57, v26 offset:384
  ds_read_b32 v58, v27 offset:384
  s_branch M_C1R_1
.p2align 6
M_LOOPS:
  v_exp_f32 v92, v60
  v_mfma_f32_32x32x16_bf16 v[76:91], v[36:39], v[48:51], 0
  v_exp_f32 v93, v61
  ds_read_b32 v53, v26 offset:256
  ds_read_b32 v54, v27 offset:256
  v_exp_f32 v94, v62
  ds_read_b32 v114, v28 offset:384
  ds_read_b32 v115, v29 offset:384
  v_exp_f32 v95, v63
  v_mfma_f32_32x32x16_bf16 v[76:91], a[64:67], a[16:19], v[76:91]
  v_exp_f32 v96, v64
  v_exp_f32 v97, v65
  v_exp_f32 v98, v66
  v_mfma_f32_32x32x16_bf16 v[76:91], a[68:71], a[20:23], v[76:91]
  v_exp_f32 v99, v67
  v_exp_f32 v100, v68
  v_exp_f32 v101, v69
  v_mfma_f32_32x32x16_bf16 v[76:91], a[72:75], a[24:27], v[76:91]
  v_exp_f32 v102, v70
  v_exp_f32 v103, v71
  v_exp_f32 v104, v72
  v_mfma_f32_32x32x16_bf16 v[76:91], a[76:79], a[28:31], v[76:91]
  v_exp_f32 v105, v73
  v_exp_f32 v106, v74
  v_exp_f32 v107, v75
  s_nop 0
  s_nop 0
  s_waitcnt lgkmcnt(0)
  v_pk_add_f32 v[24:25], v[18:19], v[114:115]
  ds_write_b32 v28, v24 offset:384
  ds_write_b32 v29, v25 offset:384
  v_add_u32_sdwa v28, v112, v12 dst_sel:DWORD dst_unused:UNUSED_PAD src0_sel:WORD_1 src1_sel:DWORD
  v_add_u32_sdwa v29, v113, v12 dst_sel:DWORD dst_unused:UNUSED_PAD src0_sel:WORD_1 src1_sel:DWORD
  ds_read_b64 v[112:113], v15 offset:128
  v_pk_add_f32 v[92:93], v[92:93], 1.0 op_sel_hi:[1,0]
  v_pk_add_f32 v[94:95], v[94:95], 1.0 op_sel_hi:[1,0]
  v_pk_add_f32 v[96:97], v[96:97], 1.0 op_sel_hi:[1,0]
  v_pk_add_f32 v[98:99], v[98:99], 1.0 op_sel_hi:[1,0]
  v_pk_add_f32 v[100:101], v[100:101], 1.0 op_sel_hi:[1,0]
  v_pk_add_f32 v[102:103], v[102:103], 1.0 op_sel_hi:[1,0]
  v_pk_add_f32 v[104:105], v[104:105], 1.0 op_sel_hi:[1,0]
  v_pk_add_f32 v[106:107], v[106:107], 1.0 op_sel_hi:[1,0]
  v_rcp_f32 v92, v92
  v_rcp_f32 v93, v93
  v_rcp_f32 v94, v94
  v_rcp_f32 v95, v95
  v_rcp_f32 v96, v96
  v_rcp_f32 v97, v97
  v_rcp_f32 v98, v98
  v_rcp_f32 v99, v99
  v_rcp_f32 v100, v100
  v_rcp_f32 v101, v101
  v_rcp_f32 v102, v102
  v_rcp_f32 v103, v103
  v_rcp_f32 v104, v104
  v_rcp_f32 v105, v105
  v_rcp_f32 v106, v106
  v_rcp_f32 v107, v107
  v_pk_mul_f32 v[18:19], v[60:61], v[92:93]
  v_pk_fma_f32 v[18:19], v[62:63], v[94:95], v[18:19]
  v_pk_fma_f32 v[18:19], v[64:65], v[96:97], v[18:19]
  v_pk_fma_f32 v[18:19], v[66:67], v[98:99], v[18:19]
  v_pk_fma_f32 v[18:19], v[68:69], v[100:101], v[18:19]
  v_pk_fma_f32 v[18:19], v[70:71], v[102:103], v[18:19]
  v_pk_fma_f32 v[18:19], v[72:73], v[104:105], v[18:19]
  v_pk_fma_f32 v[18:19], v[74:75], v[106:107], v[18:19]
  v_exp_f32 v92, v76
  v_mfma_f32_32x32x16_bf16 v[60:75], v[36:39], v[52:55], 0
  v_exp_f32 v93, v77
  ds_read_b32 v57, v26 offset:384
  ds_read_b32 v58, v27 offset:384
  v_exp_f32 v94, v78
  ds_read_b32 v114, v28 offset:0
  ds_read_b32 v115, v29 offset:0
  v_exp_f32 v95, v79
  v_mfma_f32_32x32x16_bf16 v[60:75], a[64:67], a[32:35], v[60:75]
  v_exp_f32 v96, v80
  v_exp_f32 v97, v81
  v_exp_f32 v98, v82
  v_mfma_f32_32x32x16_bf16 v[60:75], a[68:71], a[36:39], v[60:75]
  v_exp_f32 v99, v83
  v_exp_f32 v100, v84
  v_exp_f32 v101, v85
  v_mfma_f32_32x32x16_bf16 v[60:75], a[72:75], a[40:43], v[60:75]
  v_exp_f32 v102, v86
  v_exp_f32 v103, v87
  s_waitcnt lgkmcnt(4)
  v_add_u32_sdwa v26, v112, v12 dst_sel:DWORD dst_unused:UNUSED_PAD src0_sel:WORD_0 src1_sel:DWORD
  v_add_u32_sdwa v27, v113, v12 dst_sel:DWORD dst_unused:UNUSED_PAD src0_sel:WORD_0 src1_sel:DWORD
  v_exp_f32 v104, v88
  v_mfma_f32_32x32x16_bf16 v[60:75], a[76:79], a[44:47], v[60:75]
  v_exp_f32 v105, v89
  v_exp_f32 v106, v90
  v_exp_f32 v107, v91
  s_nop 0
  s_nop 0
  s_waitcnt lgkmcnt(0)
  v_pk_add_f32 v[24:25], v[18:19], v[114:115]
  ds_write_b32 v28, v24 offset:0
  ds_write_b32 v29, v25 offset:0
  v_pk_add_f32 v[92:93], v[92:93], 1.0 op_sel_hi:[1,0]
  v_pk_add_f32 v[94:95], v[94:95], 1.0 op_sel_hi:[1,0]
  v_pk_add_f32 v[96:97], v[96:97], 1.0 op_sel_hi:[1,0]
  v_pk_add_f32 v[98:99], v[98:99], 1.0 op_sel_hi:[1,0]
  v_pk_add_f32 v[100:101], v[100:101], 1.0 op_sel_hi:[1,0]
  v_pk_add_f32 v[102:103], v[102:103], 1.0 op_sel_hi:[1,0]
  v_pk_add_f32 v[104:105], v[104:105], 1.0 op_sel_hi:[1,0]
  v_pk_add_f32 v[106:107], v[106:107], 1.0 op_sel_hi:[1,0]
  v_rcp_f32 v92, v92
  v_rcp_f32 v93, v93
  v_rcp_f32 v94, v94
  v_rcp_f32 v95, v95
  v_rcp_f32 v96, v96
  v_rcp_f32 v97, v97
  v_rcp_f32 v98, v98
  v_rcp_f32 v99, v99
  v_rcp_f32 v100, v100
  v_rcp_f32 v101, v101
  v_rcp_f32 v102, v102
  v_rcp_f32 v103, v103
  v_rcp_f32 v104, v104
  v_rcp_f32 v105, v105
  v_rcp_f32 v106, v106
  v_rcp_f32 v107, v107
  v_pk_mul_f32 v[18:19], v[76:77], v[92:93]
  v_pk_fma_f32 v[18:19], v[78:79], v[94:95], v[18:19]
  v_pk_fma_f32 v[18:19], v[80:81], v[96:97], v[18:19]
  v_pk_fma_f32 v[18:19], v[82:83], v[98:99], v[18:19]
  v_pk_fma_f32 v[18:19], v[84:85], v[100:101], v[18:19]
  v_pk_fma_f32 v[18:19], v[86:87], v[102:103], v[18:19]
  v_pk_fma_f32 v[18:19], v[88:89], v[104:105], v[18:19]
  v_pk_fma_f32 v[18:19], v[90:91], v[106:107], v[18:19]
  v_exp_f32 v92, v60
  v_mfma_f32_32x32x16_bf16 v[76:91], v[36:39], v[56:59], 0
  v_exp_f32 v93, v61
  ds_read_b32 v45, v26 offset:0
  ds_read_b32 v46, v27 offset:0
  v_exp_f32 v94, v62
  ds_read_b32 v114, v28 offset:128
  ds_read_b32 v115, v29 offset:128
  v_exp_f32 v95, v63
  v_mfma_f32_32x32x16_bf16 v[76:91], a[64:67], a[48:51], v[76:91]
  v_exp_f32 v96, v64
  ds_read_b32 v36, v14 offset:64
  v_exp_f32 v97, v65
  v_exp_f32 v98, v66
  v_mfma_f32_32x32x16_bf16 v[76:91], a[68:71], a[52:55], v[76:91]
  v_exp_f32 v99, v67
  v_exp_f32 v100, v68
  v_exp_f32 v101, v69
  v_mfma_f32_32x32x16_bf16 v[76:91], a[72:75], a[56:59], v[76:91]
  v_exp_f32 v102, v70
  v_exp_f32 v103, v71
  v_exp_f32 v104, v72
  v_mfma_f32_32x32x16_bf16 v[76:91], a[76:79], a[60:63], v[76:91]
  v_exp_f32 v105, v73
  v_exp_f32 v106, v74
  v_exp_f32 v107, v75
  s_nop 0
  s_nop 0
  s_waitcnt lgkmcnt(1)
  v_pk_add_f32 v[24:25], v[18:19], v[114:115]
  ds_write_b32 v28, v24 offset:128
  ds_write_b32 v29, v25 offset:128
  v_pk_add_f32 v[92:93], v[92:93], 1.0 op_sel_hi:[1,0]
  v_pk_add_f32 v[94:95], v[94:95], 1.0 op_sel_hi:[1,0]
  v_pk_add_f32 v[96:97], v[96:97], 1.0 op_sel_hi:[1,0]
  v_pk_add_f32 v[98:99], v[98:99], 1.0 op_sel_hi:[1,0]
  v_pk_add_f32 v[100:101], v[100:101], 1.0 op_sel_hi:[1,0]
  v_pk_add_f32 v[102:103], v[102:103], 1.0 op_sel_hi:[1,0]
  v_pk_add_f32 v[104:105], v[104:105], 1.0 op_sel_hi:[1,0]
  v_pk_add_f32 v[106:107], v[106:107], 1.0 op_sel_hi:[1,0]
  v_rcp_f32 v92, v92
  v_rcp_f32 v93, v93
  v_rcp_f32 v94, v94
  v_rcp_f32 v95, v95
  v_rcp_f32 v96, v96
  v_rcp_f32 v97, v97
  v_rcp_f32 v98, v98
  v_rcp_f32 v99, v99
  v_rcp_f32 v100, v100
  v_rcp_f32 v101, v101
  v_rcp_f32 v102, v102
  v_rcp_f32 v103, v103
  v_rcp_f32 v104, v104
  v_rcp_f32 v105, v105
  v_rcp_f32 v106, v106
  v_rcp_f32 v107, v107
  v_pk_mul_f32 v[18:19], v[60:61], v[92:93]
  v_pk_fma_f32 v[18:19], v[62:63], v[94:95], v[18:19]
  v_pk_fma_f32 v[18:19], v[64:65], v[96:97], v[18:19]
  v_pk_fma_f32 v[18:19], v[66:67], v[98:99], v[18:19]
  v_pk_fma_f32 v[18:19], v[68:69], v[100:101], v[18:19]
  v_pk_fma_f32 v[18:19], v[70:71], v[102:103], v[18:19]
  v_pk_fma_f32 v[18:19], v[72:73], v[104:105], v[18:19]
  v_pk_fma_f32 v[18:19], v[74:75], v[106:107], v[18:19]
  v_exp_f32 v92, v76
  v_mfma_f32_32x32x16_bf16 v[60:75], v[40:43], v[44:47], 0
  v_exp_f32 v93, v77
  ds_read_b32 v49, v26 offset:128
  ds_read_b32 v50, v27 offset:128
  v_exp_f32 v94, v78
  ds_read_b32 v114, v28 offset:256
  ds_read_b32 v115, v29 offset:256
  v_exp_f32 v95, v79
  s_waitcnt vmcnt(0)
  v_mfma_f32_32x32x16_bf16 v[60:75], a[80:83], a[0:3], v[60:75]
  v_exp_f32 v96, v80
  v_exp_f32 v97, v81
  s_waitcnt lgkmcnt(6)
  v_mad_u32_u16 v5, v36, s36, v4
  v_cmp_le_i16 vcc, 0, v36
  v_exp_f32 v98, v82
  v_mfma_f32_32x32x16_bf16 v[60:75], a[84:87], a[4:7], v[60:75]
  v_exp_f32 v99, v83
  buffer_load_dwordx4 a[64:67], v5, s[4:7], 0 offen offset:0
  buffer_load_dwordx4 a[68:71], v5, s[4:7], 0 offen offset:16
  buffer_load_dwordx4 a[72:75], v5, s[4:7], 0 offen offset:32
  buffer_load_dwordx4 a[76:79], v5, s[4:7], 0 offen offset:48
  v_cndmask_b32 v37, 0, v10, vcc
  v_cndmask_b32 v38, 0, v11, vcc
  v_exp_f32 v100, v84
  v_exp_f32 v101, v85
  v_mfma_f32_32x32x16_bf16 v[60:75], a[88:91], a[8:11], v[60:75]
  v_exp_f32 v102, v86
  v_exp_f32 v103, v87
  v_exp_f32 v104, v88
  v_mfma_f32_32x32x16_bf16 v[60:75], a[92:95], a[12:15], v[60:75]
  v_exp_f32 v105, v89
  v_exp_f32 v106, v90
  v_exp_f32 v107, v91
  s_nop 0
  s_nop 0
  s_waitcnt lgkmcnt(0)
  v_pk_add_f32 v[24:25], v[18:19], v[114:115]
  ds_write_b32 v28, v24 offset:256
  ds_write_b32 v29, v25 offset:256
  v_pk_add_f32 v[92:93], v[92:93], 1.0 op_sel_hi:[1,0]
  v_pk_add_f32 v[94:95], v[94:95], 1.0 op_sel_hi:[1,0]
  v_pk_add_f32 v[96:97], v[96:97], 1.0 op_sel_hi:[1,0]
  v_pk_add_f32 v[98:99], v[98:99], 1.0 op_sel_hi:[1,0]
  v_pk_add_f32 v[100:101], v[100:101], 1.0 op_sel_hi:[1,0]
  v_pk_add_f32 v[102:103], v[102:103], 1.0 op_sel_hi:[1,0]
  v_pk_add_f32 v[104:105], v[104:105], 1.0 op_sel_hi:[1,0]
  v_pk_add_f32 v[106:107], v[106:107], 1.0 op_sel_hi:[1,0]
  v_rcp_f32 v92, v92
  v_rcp_f32 v93, v93
  v_rcp_f32 v94, v94
  v_rcp_f32 v95, v95
  v_rcp_f32 v96, v96
  v_rcp_f32 v97, v97
  v_rcp_f32 v98, v98
  v_rcp_f32 v99, v99
  v_rcp_f32 v100, v100
  v_rcp_f32 v101, v101
  v_rcp_f32 v102, v102
  v_rcp_f32 v103, v103
  v_rcp_f32 v104, v104
  v_rcp_f32 v105, v105
  v_rcp_f32 v106, v106
  v_rcp_f32 v107, v107
  v_pk_mul_f32 v[18:19], v[76:77], v[92:93]
  v_pk_fma_f32 v[18:19], v[78:79], v[94:95], v[18:19]
  v_pk_fma_f32 v[18:19], v[80:81], v[96:97], v[18:19]
  v_pk_fma_f32 v[18:19], v[82:83], v[98:99], v[18:19]
  v_pk_fma_f32 v[18:19], v[84:85], v[100:101], v[18:19]
  v_pk_fma_f32 v[18:19], v[86:87], v[102:103], v[18:19]
  v_pk_fma_f32 v[18:19], v[88:89], v[104:105], v[18:19]
  v_pk_fma_f32 v[18:19], v[90:91], v[106:107], v[18:19]
  s_sub_u32 s34, s34, 1
  s_cmp_eq_u32 s34, 0
  s_cbranch_scc1 M_FINS
  v_exp_f32 v92, v60
  v_mfma_f32_32x32x16_bf16 v[76:91], v[40:43], v[48:51], 0
  v_exp_f32 v93, v61
  ds_read_b32 v53, v26 offset:256
  ds_read_b32 v54, v27 offset:256
  v_exp_f32 v94, v62
  ds_read_b32 v114, v28 offset:384
  ds_read_b32 v115, v29 offset:384
  v_exp_f32 v95, v63
  v_mfma_f32_32x32x16_bf16 v[76:91], a[80:83], a[16:19], v[76:91]
  v_exp_f32 v96, v64
  v_exp_f32 v97, v65
  v_exp_f32 v98, v66
  v_mfma_f32_32x32x16_bf16 v[76:91], a[84:87], a[20:23], v[76:91]
  v_exp_f32 v99, v67
  v_exp_f32 v100, v68
  v_exp_f32 v101, v69
  v_mfma_f32_32x32x16_bf16 v[76:91], a[88:91], a[24:27], v[76:91]
  v_exp_f32 v102, v70
  v_exp_f32 v103, v71
  v_exp_f32 v104, v72
  v_mfma_f32_32x32x16_bf16 v[76:91], a[92:95], a[28:31], v[76:91]
  v_exp_f32 v105, v73
  v_exp_f32 v106, v74
  v_exp_f32 v107, v75
  s_nop 0
  s_nop 0
  s_waitcnt lgkmcnt(0)
  v_pk_add_f32 v[24:25], v[18:19], v[114:115]
  ds_write_b32 v28, v24 offset:384
  ds_write_b32 v29, v25 offset:384
  v_add_u32_sdwa v28, v112, v12 dst_sel:DWORD dst_unused:UNUSED_PAD src0_sel:WORD_1 src1_sel:DWORD
  v_add_u32_sdwa v29, v113, v12 dst_sel:DWORD dst_unused:UNUSED_PAD src0_sel:WORD_1 src1_sel:DWORD
  ds_read_b64 v[112:113], v15 offset:256
  v_pk_add_f32 v[92:93], v[92:93], 1.0 op_sel_hi:[1,0]
  v_pk_add_f32 v[94:95], v[94:95], 1.0 op_sel_hi:[1,0]
  v_pk_add_f32 v[96:97], v[96:97], 1.0 op_sel_hi:[1,0]
  v_pk_add_f32 v[98:99], v[98:99], 1.0 op_sel_hi:[1,0]
  v_pk_add_f32 v[100:101], v[100:101], 1.0 op_sel_hi:[1,0]
  v_pk_add_f32 v[102:103], v[102:103], 1.0 op_sel_hi:[1,0]
  v_pk_add_f32 v[104:105], v[104:105], 1.0 op_sel_hi:[1,0]
  v_pk_add_f32 v[106:107], v[106:107], 1.0 op_sel_hi:[1,0]
  v_rcp_f32 v92, v92
  v_rcp_f32 v93, v93
  v_rcp_f32 v94, v94
  v_rcp_f32 v95, v95
  v_rcp_f32 v96, v96
  v_rcp_f32 v97, v97
  v_rcp_f32 v98, v98
  v_rcp_f32 v99, v99
  v_rcp_f32 v100, v100
  v_rcp_f32 v101, v101
  v_rcp_f32 v102, v102
  v_rcp_f32 v103, v103
  v_rcp_f32 v104, v104
  v_rcp_f32 v105, v105
  v_rcp_f32 v106, v106
  v_rcp_f32 v107, v107
  v_pk_mul_f32 v[18:19], v[60:61], v[92:93]
  v_pk_fma_f32 v[18:19], v[62:63], v[94:95], v[18:19]
  v_pk_fma_f32 v[18:19], v[64:65], v[96:97], v[18:19]
  v_pk_fma_f32 v[18:19], v[66:67], v[98:99], v[18:19]
  v_pk_fma_f32 v[18:19], v[68:69], v[100:101], v[18:19]
  v_pk_fma_f32 v[18:19], v[70:71], v[102:103], v[18:19]
  v_pk_fma_f32 v[18:19], v[72:73], v[104:105], v[18:19]
  v_pk_fma_f32 v[18:19], v[74:75], v[106:107], v[18:19]
  v_exp_f32 v92, v76
  v_mfma_f32_32x32x16_bf16 v[60:75], v[40:43], v[52:55], 0
  v_exp_f32 v93, v77
  ds_read_b32 v57, v26 offset:384
  ds_read_b32 v58, v27 offset:384
  v_exp_f32 v94, v78
  ds_read_b32 v114, v28 offset:0
  ds_read_b32 v115, v29 offset:0
  v_exp_f32 v95, v79
  v_mfma_f32_32x32x16_bf16 v[60:75], a[80:83], a[32:35], v[60:75]
  v_exp_f32 v96, v80
  v_exp_f32 v97, v81
  v_exp_f32 v98, v82
  v_mfma_f32_32x32x16_bf16 v[60:75], a[84:87], a[36:39], v[60:75]
  v_exp_f32 v99, v83
  v_exp_f32 v100, v84
  v_exp_f32 v101, v85
  v_mfma_f32_32x32x16_bf16 v[60:75], a[88:91], a[40:43], v[60:75]
  v_exp_f32 v102, v86
  v_exp_f32 v103, v87
  s_waitcnt lgkmcnt(4)
  v_add_u32_sdwa v26, v112, v12 dst_sel:DWORD dst_unused:UNUSED_PAD src0_sel:WORD_0 src1_sel:DWORD
  v_add_u32_sdwa v27, v113, v12 dst_sel:DWORD dst_unused:UNUSED_PAD src0_sel:WORD_0 src1_sel:DWORD
  v_exp_f32 v104, v88
  v_mfma_f32_32x32x16_bf16 v[60:75], a[92:95], a[44:47], v[60:75]
  v_exp_f32 v105, v89
  v_exp_f32 v106, v90
  v_exp_f32 v107, v91
  s_nop 0
  s_nop 0
  s_waitcnt lgkmcnt(0)
  v_pk_add_f32 v[24:25], v[18:19], v[114:115]
  ds_write_b32 v28, v24 offset:0
  ds_write_b32 v29, v25 offset:0
  v_pk_add_f32 v[92:93], v[92:93], 1.0 op_sel_hi:[1,0]
  v_pk_add_f32 v[94:95], v[94:95], 1.0 op_sel_hi:[1,0]
  v_pk_add_f32 v[96:97], v[96:97], 1.0 op_sel_hi:[1,0]
  v_pk_add_f32 v[98:99], v[98:99], 1.0 op_sel_hi:[1,0]
  v_pk_add_f32 v[100:101], v[100:101], 1.0 op_sel_hi:[1,0]
  v_pk_add_f32 v[102:103], v[102:103], 1.0 op_sel_hi:[1,0]
  v_pk_add_f32 v[104:105], v[104:105], 1.0 op_sel_hi:[1,0]
  v_pk_add_f32 v[106:107], v[106:107], 1.0 op_sel_hi:[1,0]
  v_rcp_f32 v92, v92
  v_rcp_f32 v93, v93
  v_rcp_f32 v94, v94
  v_rcp_f32 v95, v95
  v_rcp_f32 v96, v96
  v_rcp_f32 v97, v97
  v_rcp_f32 v98, v98
  v_rcp_f32 v99, v99
  v_rcp_f32 v100, v100
  v_rcp_f32 v101, v101
  v_rcp_f32 v102, v102
  v_rcp_f32 v103, v103
  v_rcp_f32 v104, v104
  v_rcp_f32 v105, v105
  v_rcp_f32 v106, v106
  v_rcp_f32 v107, v107
  v_pk_mul_f32 v[18:19], v[76:77], v[92:93]
  v_pk_fma_f32 v[18:19], v[78:79], v[94:95], v[18:19]
  v_pk_fma_f32 v[18:19], v[80:81], v[96:97], v[18:19]
  v_pk_fma_f32 v[18:19], v[82:83], v[98:99], v[18:19]
  v_pk_fma_f32 v[18:19], v[84:85], v[100:101], v[18:19]
  v_pk_fma_f32 v[18:19], v[86:87], v[102:103], v[18:19]
  v_pk_fma_f32 v[18:19], v[88:89], v[104:105], v[18:19]
  v_pk_fma_f32 v[18:19], v[90:91], v[106:107], v[18:19]
  v_exp_f32 v92, v60
  v_mfma_f32_32x32x16_bf16 v[76:91], v[40:43], v[56:59], 0
  v_exp_f32 v93, v61
  ds_read_b32 v45, v26 offset:0
  ds_read_b32 v46, v27 offset:0
  v_exp_f32 v94, v62
  ds_read_b32 v114, v28 offset:128
  ds_read_b32 v115, v29 offset:128
  v_exp_f32 v95, v63
  v_mfma_f32_32x32x16_bf16 v[76:91], a[80:83], a[48:51], v[76:91]
  v_exp_f32 v96, v64
  ds_read_b32 v40, v14 offset:96
  v_exp_f32 v97, v65
  v_exp_f32 v98, v66
  v_mfma_f32_32x32x16_bf16 v[76:91], a[84:87], a[52:55], v[76:91]
  v_exp_f32 v99, v67
  v_exp_f32 v100, v68
  v_exp_f32 v101, v69
  v_mfma_f32_32x32x16_bf16 v[76:91], a[88:91], a[56:59], v[76:91]
  v_exp_f32 v102, v70
  v_exp_f32 v103, v71
  v_exp_f32 v104, v72
  v_mfma_f32_32x32x16_bf16 v[76:91], a[92:95], a[60:63], v[76:91]
  v_exp_f32 v105, v73
  v_exp_f32 v106, v74
  v_exp_f32 v107, v75
  s_nop 0
  s_nop 0
  s_waitcnt lgkmcnt(1)
  v_pk_add_f32 v[24:25], v[18:19], v[114:115]
  ds_write_b32 v28, v24 offset:128
  ds_write_b32 v29, v25 offset:128
  v_pk_add_f32 v[92:93], v[92:93], 1.0 op_sel_hi:[1,0]
  v_pk_add_f32 v[94:95], v[94:95], 1.0 op_sel_hi:[1,0]
  v_pk_add_f32 v[96:97], v[96:97], 1.0 op_sel_hi:[1,0]
  v_pk_add_f32 v[98:99], v[98:99], 1.0 op_sel_hi:[1,0]
  v_pk_add_f32 v[100:101], v[100:101], 1.0 op_sel_hi:[1,0]
  v_pk_add_f32 v[102:103], v[102:103], 1.0 op_sel_hi:[1,0]
  v_pk_add_f32 v[104:105], v[104:105], 1.0 op_sel_hi:[1,0]
  v_pk_add_f32 v[106:107], v[106:107], 1.0 op_sel_hi:[1,0]
  v_rcp_f32 v92, v92
  v_rcp_f32 v93, v93
  v_rcp_f32 v94, v94
  v_rcp_f32 v95, v95
  v_rcp_f32 v96, v96
  v_rcp_f32 v97, v97
  v_rcp_f32 v98, v98
  v_rcp_f32 v99, v99
  v_rcp_f32 v100, v100
  v_rcp_f32 v101, v101
  v_rcp_f32 v102, v102
  v_rcp_f32 v103, v103
  v_rcp_f32 v104, v104
  v_rcp_f32 v105, v105
  v_rcp_f32 v106, v106
  v_rcp_f32 v107, v107
  v_pk_mul_f32 v[18:19], v[60:61], v[92:93]
  v_pk_fma_f32 v[18:19], v[62:63], v[94:95], v[18:19]
  v_pk_fma_f32 v[18:19], v[64:65], v[96:97], v[18:19]
  v_pk_fma_f32 v[18:19], v[66:67], v[98:99], v[18:19]
  v_pk_fma_f32 v[18:19], v[68:69], v[100:101], v[18:19]
  v_pk_fma_f32 v[18:19], v[70:71], v[102:103], v[18:19]
  v_pk_fma_f32 v[18:19], v[72:73], v[104:105], v[18:19]
  v_pk_fma_f32 v[18:19], v[74:75], v[106:107], v[18:19]
  v_exp_f32 v92, v76
  v_mfma_f32_32x32x16_bf16 v[60:75], v[36:39], v[44:47], 0
  v_exp_f32 v93, v77
  ds_read_b32 v49, v26 offset:128
  ds_read_b32 v50, v27 offset:128
  v_exp_f32 v94, v78
  ds_read_b32 v114, v28 offset:256
  ds_read_b32 v115, v29 offset:256
  v_exp_f32 v95, v79
  s_waitcnt vmcnt(0)
  v_mfma_f32_32x32x16_bf16 v[60:75], a[64:67], a[0:3], v[60:75]
  v_exp_f32 v96, v80
  v_add_u32 v14, 64, v14
  v_add_u32 v15, 256, v15
  v_exp_f32 v97, v81
  s_waitcnt lgkmcnt(6)
  v_mad_u32_u16 v5, v40, s36, v4
  v_cmp_le_i16 vcc, 0, v40
  v_exp_f32 v98, v82
  v_mfma_f32_32x32x16_bf16 v[60:75], a[68:71], a[4:7], v[60:75]
  v_exp_f32 v99, v83
  buffer_load_dwordx4 a[80:83], v5, s[4:7], 0 offen offset:0
  buffer_load_dwordx4 a[84:87], v5, s[4:7], 0 offen offset:16
  buffer_load_dwordx4 a[88:91], v5, s[4:7], 0 offen offset:32
  buffer_load_dwordx4 a[92:95], v5, s[4:7], 0 offen offset:48
  v_cndmask_b32 v41, 0, v10, vcc
  v_cndmask_b32 v42, 0, v11, vcc
  v_exp_f32 v100, v84
  v_exp_f32 v101, v85
  v_mfma_f32_32x32x16_bf16 v[60:75], a[72:75], a[8:11], v[60:75]
  v_exp_f32 v102, v86
  v_exp_f32 v103, v87
  v_exp_f32 v104, v88
  v_mfma_f32_32x32x16_bf16 v[60:75], a[76:79], a[12:15], v[60:75]
  v_exp_f32 v105, v89
  v_exp_f32 v106, v90
  v_exp_f32 v107, v91
  s_nop 0
  s_nop 0
  s_waitcnt lgkmcnt(0)
  v_pk_add_f32 v[24:25], v[18:19], v[114:115]
  ds_write_b32 v28, v24 offset:256
  ds_write_b32 v29, v25 offset:256
  v_pk_add_f32 v[92:93], v[92:93], 1.0 op_sel_hi:[1,0]
  v_pk_add_f32 v[94:95], v[94:95], 1.0 op_sel_hi:[1,0]
  v_pk_add_f32 v[96:97], v[96:97], 1.0 op_sel_hi:[1,0]
  v_pk_add_f32 v[98:99], v[98:99], 1.0 op_sel_hi:[1,0]
  v_pk_add_f32 v[100:101], v[100:101], 1.0 op_sel_hi:[1,0]
  v_pk_add_f32 v[102:103], v[102:103], 1.0 op_sel_hi:[1,0]
  v_pk_add_f32 v[104:105], v[104:105], 1.0 op_sel_hi:[1,0]
  v_pk_add_f32 v[106:107], v[106:107], 1.0 op_sel_hi:[1,0]
  v_rcp_f32 v92, v92
  v_rcp_f32 v93, v93
  v_rcp_f32 v94, v94
  v_rcp_f32 v95, v95
  v_rcp_f32 v96, v96
  v_rcp_f32 v97, v97
  v_rcp_f32 v98, v98
  v_rcp_f32 v99, v99
  v_rcp_f32 v100, v100
  v_rcp_f32 v101, v101
  v_rcp_f32 v102, v102
  v_rcp_f32 v103, v103
  v_rcp_f32 v104, v104
  v_rcp_f32 v105, v105
  v_rcp_f32 v106, v106
  v_rcp_f32 v107, v107
  v_pk_mul_f32 v[18:19], v[76:77], v[92:93]
  v_pk_fma_f32 v[18:19], v[78:79], v[94:95], v[18:19]
  v_pk_fma_f32 v[18:19], v[80:81], v[96:97], v[18:19]
  v_pk_fma_f32 v[18:19], v[82:83], v[98:99], v[18:19]
  v_pk_fma_f32 v[18:19], v[84:85], v[100:101], v[18:19]
  v_pk_fma_f32 v[18:19], v[86:87], v[102:103], v[18:19]
  v_pk_fma_f32 v[18:19], v[88:89], v[104:105], v[18:19]
  v_pk_fma_f32 v[18:19], v[90:91], v[106:107], v[18:19]
  s_sub_u32 s34, s34, 1
  s_cmp_lg_u32 s34, 0
  s_cbranch_scc1 M_LOOPS
M_FINS:
  ds_read_b32 v114, v28 offset:384
  ds_read_b32 v115, v29 offset:384
  s_waitcnt lgkmcnt(0)
  v_pk_add_f32 v[24:25], v[18:19], v[114:115]
  ds_write_b32 v28, v24 offset:384
  ds_write_b32 v29, v25 offset:384
  s_branch M_DONE
M_DONE:
  s_cmp_lg_u32 s49, 0
  s_cbranch_scc1 M_DONE2
  v_lshlrev_b32 v28, 4, v1
  v_lshrrev_b32 v29, 4, v1
  s_and_b32 s40, s30, 1
  v_lshlrev_b32 v29, 3, v29
  s_lshl_b32 s45, s40, 6
  s_add_u32 s45, s45, 5817856
  s_lshl_b32 s40, s40, 13
  s_add_u32 s40, s40, 5799936
  s_add_u32 s41, s40, 4096
  buffer_load_dwordx4 a[96:99], v28, s[8:11], s40 offen offset:0
  buffer_load_dwordx4 a[100:103], v28, s[8:11], s40 offen offset:1024
  buffer_load_dwordx4 a[104:107], v28, s[8:11], s40 offen offset:2048
  buffer_load_dwordx4 a[108:111], v28, s[8:11], s40 offen offset:3072
  buffer_load_dwordx4 a[112:115], v28, s[8:11], s41 offen offset:0
  buffer_load_dwordx4 a[116:119], v28, s[8:11], s41 offen offset:1024
  buffer_load_dwordx4 a[120:123], v28, s[8:11], s41 offen offset:2048
  buffer_load_dwordx4 a[124:127], v28, s[8:11], s41 offen offset:3072
  buffer_load_dwordx2 v[108:109], v29, s[8:11], s45 offen offset:0
  buffer_load_dwordx2 v[110:111], v29, s[8:11], s45 offen offset:32
  s_mov_b32 s49, 1
M_DONE2:
  v_add_f32 v16, v16, v17
  v_mov_b32 v2, 1
  v_mov_b32 v31, 60176
  v_cmp_ngt_f32 vcc, s39, v16
  s_nop 0
  s_mov_b64 exec, vcc
  ds_write_b32 v31, v2
  s_mov_b64 exec, -1
  v_and_b32 v30, 15, v1
  s_lshr_b32 s41, s30, 1
  s_lshl_b32 s41, s41, 4
  v_add_u32 v30, s41, v30
  v_lshlrev_b32 v2, 2, v30
  v_add_u32 v2, 59664, v2
  ds_read_b32 v112, v2 offset:256
  ds_read_b32 v2, v2
  v_lshrrev_b32 v17, 4, v1
  v_lshlrev_b32 v114, 5, v17
  v_add_u32 v114, 21648, v114
  s_mov_b32 s45, 528
  v_mad_u32_u24 v3, v30, s45, v114
  v_add_u32 v114, 21120, v114
  s_waitcnt lgkmcnt(0)
  v_and_b32 v26, 0xff, v112
  v_lshrrev_b32 v112, 8, v112
  v_mad_u32_u24 v26, v26, s45, v114
  v_add_u32 v26, 528, v26
  v_cmp_lt_i32 vcc, 0, v112
  s_nop 1
  v_cndmask_b32 v27, v114, v26, vcc
  s_waitcnt vmcnt(0)
  s_barrier
  ds_read_b32 v31, v31
  s_cmp_ge_u32 s30, 6
  s_cbranch_scc1 M_EPD
  ds_read_b128 v[60:63], v3 offset:0
  ds_read_b128 v[64:67], v3 offset:16
  ds_read_b128 v[68:71], v3 offset:128
  ds_read_b128 v[72:75], v3 offset:144
  ds_read_b128 v[76:79], v3 offset:256
  ds_read_b128 v[80:83], v3 offset:272
  ds_read_b128 v[84:87], v3 offset:384
  ds_read_b128 v[88:91], v3 offset:400
M_CARRY:
  ds_read_b128 v[92:95], v27 offset:0
  ds_read_b128 v[96:99], v27 offset:16
  ds_read_b128 v[100:103], v27 offset:128
  ds_read_b128 v[104:107], v27 offset:144
  ds_read_b128 v[36:39], v27 offset:256
  ds_read_b128 v[40:43], v27 offset:272
  ds_read_b128 v[116:119], v27 offset:384
  ds_read_b128 v[120:123], v27 offset:400
  v_add_u32 v26, 528, v26
  v_add_u32 v112, -1, v112
  v_cmp_lt_i32 vcc, 0, v112
  s_nop 1
  v_cndmask_b32 v27, v114, v26, vcc
  s_waitcnt lgkmcnt(7)
  v_pk_add_f32 v[60:61], v[60:61], v[92:93]
  v_pk_add_f32 v[62:63], v[62:63], v[94:95]
  s_waitcnt lgkmcnt(6)
  v_pk_add_f32 v[64:65], v[64:65], v[96:97]
  v_pk_add_f32 v[66:67], v[66:67], v[98:99]
  s_waitcnt lgkmcnt(5)
  v_pk_add_f32 v[68:69], v[68:69], v[100:101]
  v_pk_add_f32 v[70:71], v[70:71], v[102:103]
  s_waitcnt lgkmcnt(4)
  v_pk_add_f32 v[72:73], v[72:73], v[104:105]
  v_pk_add_f32 v[74:75], v[74:75], v[106:107]
  s_waitcnt lgkmcnt(3)
  v_pk_add_f32 v[76:77], v[76:77], v[36:37]
  v_pk_add_f32 v[78:79], v[78:79], v[38:39]
  s_waitcnt lgkmcnt(2)
  v_pk_add_f32 v[80:81], v[80:81], v[40:41]
  v_pk_add_f32 v[82:83], v[82:83], v[42:43]
  s_waitcnt lgkmcnt(1)
  v_pk_add_f32 v[84:85], v[84:85], v[116:117]
  v_pk_add_f32 v[86:87], v[86:87], v[118:119]
  s_waitcnt lgkmcnt(0)
  v_pk_add_f32 v[88:89], v[88:89], v[120:121]
  v_pk_add_f32 v[90:91], v[90:91], v[122:123]
  s_cbranch_vccnz M_CARRY
  v_readfirstlane_b32 s40, v31
  s_nop 0
  s_andn2_b32 s40, s40, s32
  s_cbranch_scc1 M_RESTART
  s_cmp_lg_u32 s35, 0
  s_cbranch_scc1 M_FOLD
  s_mov_b32 s40, 0xffff0000
  s_waitcnt lgkmcnt(0)
  v_cvt_pk_bf16_f32 v92, v60, v61
  v_cvt_pk_bf16_f32 v93, v62, v63
  v_cvt_pk_bf16_f32 v94, v64, v65
  v_cvt_pk_bf16_f32 v95, v66, v67
  s_nop 1
  v_mfma_f32_16x16x32_bf16 v[18:21], a[96:99], v[92:95], 0
  v_mfma_f32_16x16x32_bf16 v[22:25], a[112:115], v[92:95], 0
  v_lshlrev_b32 v32, 16, v92
  v_and_b32 v33, s40, v92
  v_sub_f32 v60, v60, v32
  v_sub_f32 v61, v61, v33
  v_lshlrev_b32 v32, 16, v93
  v_and_b32 v33, s40, v93
  v_sub_f32 v62, v62, v32
  v_sub_f32 v63, v63, v33
  v_lshlrev_b32 v32, 16, v94
  v_and_b32 v33, s40, v94
  v_sub_f32 v64, v64, v32
  v_sub_f32 v65, v65, v33
  v_lshlrev_b32 v32, 16, v95
  v_and_b32 v33, s40, v95
  v_sub_f32 v66, v66, v32
  v_sub_f32 v67, v67, v33
  v_cvt_pk_bf16_f32 v96, v60, v61
  v_cvt_pk_bf16_f32 v97, v62, v63
  v_cvt_pk_bf16_f32 v98, v64, v65
  v_cvt_pk_bf16_f32 v99, v66, v67
  s_nop 1
  v_mfma_f32_16x16x32_bf16 v[18:21], a[96:99], v[96:99], v[18:21]
  v_mfma_f32_16x16x32_bf16 v[22:25], a[112:115], v[96:99], v[22:25]
  v_cvt_pk_bf16_f32 v100, v68, v69
  v_cvt_pk_bf16_f32 v101, v70, v71
  v_cvt_pk_bf16_f32 v102, v72, v73
  v_cvt_pk_bf16_f32 v103, v74, v75
  s_nop 1
  v_mfma_f32_16x16x32_bf16 v[18:21], a[100:103], v[100:103], v[18:21]
  v_mfma_f32_16x16x32_bf16 v[22:25], a[116:119], v[100:103], v[22:25]
  v_lshlrev_b32 v32, 16, v100
  v_and_b32 v33, s40, v100
  v_sub_f32 v68, v68, v32
  v_sub_f32 v69, v69, v33
  v_lshlrev_b32 v32, 16, v101
  v_and_b32 v33, s40, v101
  v_sub_f32 v70, v70, v32
  v_sub_f32 v71, v71, v33
  v_lshlrev_b32 v32, 16, v102
  v_and_b32 v33, s40, v102
  v_sub_f32 v72, v72, v32
  v_sub_f32 v73, v73, v33
  v_lshlrev_b32 v32, 16, v103
  v_and_b32 v33, s40, v103
  v_sub_f32 v74, v74, v32
  v_sub_f32 v75, v75, v33
  v_cvt_pk_bf16_f32 v104, v68, v69
  v_cvt_pk_bf16_f32 v105, v70, v71
  v_cvt_pk_bf16_f32 v106, v72, v73
  v_cvt_pk_bf16_f32 v107, v74, v75
  s_nop 1
  v_mfma_f32_16x16x32_bf16 v[18:21], a[100:103], v[104:107], v[18:21]
  v_mfma_f32_16x16x32_bf16 v[22:25], a[116:119], v[104:107], v[22:25]
  v_cvt_pk_bf16_f32 v92, v76, v77
  v_cvt_pk_bf16_f32 v93, v78, v79
  v_cvt_pk_bf16_f32 v94, v80, v81
  v_cvt_pk_bf16_f32 v95, v82, v83
  s_nop 1
  v_mfma_f32_16x16x32_bf16 v[18:21], a[104:107], v[92:95], v[18:21]
  v_mfma_f32_16x16x32_bf16 v[22:25], a[120:123], v[92:95], v[22:25]
  v_lshlrev_b32 v32, 16, v92
  v_and_b32 v33, s40, v92
  v_sub_f32 v76, v76, v32
  v_sub_f32 v77, v77, v33
  v_lshlrev_b32 v32, 16, v93
  v_and_b32 v33, s40, v93
  v_sub_f32 v78, v78, v32
  v_sub_f32 v79, v79, v33
  v_lshlrev_b32 v32, 16, v94
  v_and_b32 v33, s40, v94
  v_sub_f32 v80, v80, v32
  v_sub_f32 v81, v81, v33
  v_lshlrev_b32 v32, 16, v95
  v_and_b32 v33, s40, v95
  v_sub_f32 v82, v82, v32
  v_sub_f32 v83, v83, v33
  v_cvt_pk_bf16_f32 v96, v76, v77
  v_cvt_pk_bf16_f32 v97, v78, v79
  v_cvt_pk_bf16_f32 v98, v80, v81
  v_cvt_pk_bf16_f32 v99, v82, v83
  s_nop 1
  v_mfma_f32_16x16x32_bf16 v[18:21], a[104:107], v[96:99], v[18:21]
  v_mfma_f32_16x16x32_bf16 v[22:25], a[120:123], v[96:99], v[22:25]
  v_cvt_pk_bf16_f32 v100, v84, v85
  v_cvt_pk_bf16_f32 v101, v86, v87
  v_cvt_pk_bf16_f32 v102, v88, v89
  v_cvt_pk_bf16_f32 v103, v90, v91
  s_nop 1
  v_mfma_f32_16x16x32_bf16 v[18:21], a[108:111], v[100:103], v[18:21]
  v_mfma_f32_16x16x32_bf16 v[22:25], a[124:127], v[100:103], v[22:25]
  v_lshlrev_b32 v32, 16, v100
  v_and_b32 v33, s40, v100
  v_sub_f32 v84, v84, v32
  v_sub_f32 v85, v85, v33
  v_lshlrev_b32 v32, 16, v101
  v_and_b32 v33, s40, v101
  v_sub_f32 v86, v86, v32
  v_sub_f32 v87, v87, v33
  v_lshlrev_b32 v32, 16, v102
  v_and_b32 v33, s40, v102
  v_sub_f32 v88, v88, v32
  v_sub_f32 v89, v89, v33
  v_lshlrev_b32 v32, 16, v103
  v_and_b32 v33, s40, v103
  v_sub_f32 v90, v90, v32
  v_sub_f32 v91, v91, v33
  v_cvt_pk_bf16_f32 v104, v84, v85
  v_cvt_pk_bf16_f32 v105, v86, v87
  v_cvt_pk_bf16_f32 v106, v88, v89
  v_cvt_pk_bf16_f32 v107, v90, v91
  s_nop 1
  v_mfma_f32_16x16x32_bf16 v[18:21], a[108:111], v[104:107], v[18:21]
  v_mfma_f32_16x16x32_bf16 v[22:25], a[124:127], v[104:107], v[22:25]
  v_cvt_f32_u32 v2, v2
  v_lshlrev_b32 v60, 16, v108
  v_and_b32 v61, s40, v108
  v_lshlrev_b32 v62, 16, v109
  v_and_b32 v63, s40, v109
  v_lshlrev_b32 v64, 16, v110
  v_and_b32 v65, s40, v110
  v_lshlrev_b32 v66, 16, v111
  v_and_b32 v67, s40, v111
  v_mul_f32 v60, v60, v2
  v_mul_f32 v61, v61, v2
  v_mul_f32 v62, v62, v2
  v_mul_f32 v63, v63, v2
  v_mul_f32 v64, v64, v2
  v_mul_f32 v65, v65, v2
  v_mul_f32 v66, v66, v2
  v_mul_f32 v67, v67, v2
  s_mov_b32 s42, 0xbf317218
  v_add_u32 v3, s28, v30
  v_lshlrev_b32 v3, 7, v3
  v_lshl_add_u32 v3, v17, 3, v3
  s_and_b32 s43, s30, 1
  s_lshl_b32 s43, s43, 6
  v_cmp_gt_u32 vcc, s29, v30
  s_nop 0
  s_mov_b64 exec, vcc
  v_fma_f32 v60, v18, s42, v60
  v_fma_f32 v61, v19, s42, v61
  v_fma_f32 v62, v20, s42, v62
  v_fma_f32 v63, v21, s42, v63
  v_fma_f32 v64, v22, s42, v64
  v_fma_f32 v65, v23, s42, v65
  v_fma_f32 v66, v24, s42, v66
  v_fma_f32 v67, v25, s42, v67
  v_cvt_pk_bf16_f32 v92, v60, v61
  v_cvt_pk_bf16_f32 v93, v62, v63
  buffer_store_dwordx2 v[92:93], v3, s[16:19], s43 offen offset:0
  v_cvt_pk_bf16_f32 v94, v64, v65
  v_cvt_pk_bf16_f32 v95, v66, v67
  buffer_store_dwordx2 v[94:95], v3, s[16:19], s43 offen offset:32
M_END:
M_EXIT:
  s_endpgm
M_EPD:
  s_waitcnt lgkmcnt(0)
  v_readfirstlane_b32 s40, v31
  s_nop 0
  s_andn2_b32 s40, s40, s32
  s_cbranch_scc1 M_RESTART
  s_cmp_lg_u32 s35, 0
  s_cbranch_scc1 M_NEXT
  s_branch M_END
M_RESTART:
M_SLOW:
  s_waitcnt lgkmcnt(0)
  s_barrier
  s_mov_b32 s51, 12
  s_mov_b32 s32, 1
  s_mov_b32 s31, 0
  v_lshlrev_b32 v3, 4, v0
  v_mov_b32 v92, 0
  v_mov_b32 v93, 0
  v_mov_b32 v94, 0
  v_mov_b32 v95, 0
  v_add_u32 v2, 21648, v3
  ds_write_b128 v2, v[92:95] offset:0
  ds_write_b128 v2, v[92:95] offset:8192
  v_cmp_gt_u32 vcc, 329, v0
  s_nop 0
  s_mov_b64 exec, vcc
  ds_write_b128 v2, v[92:95] offset:16384
  s_mov_b64 exec, -1
  v_add_u32 v2, 59664, v3
  v_cmp_gt_u32 vcc, 16, v0
  s_nop 0
  s_mov_b64 exec, vcc
  ds_write_b128 v2, v[92:95] offset:0
  s_mov_b64 exec, -1
  s_branch M_HEAD
M_FOLD:
  s_bitcmp1_b32 s30, 0
  s_cbranch_scc1 M_NEXT
  v_cmp_gt_u32 vcc, 40, v30
  s_waitcnt lgkmcnt(0)
  s_mov_b64 exec, vcc
  ds_write_b128 v3, v[60:63] offset:0
  ds_write_b128 v3, v[64:67] offset:16
  ds_write_b128 v3, v[68:71] offset:128
  ds_write_b128 v3, v[72:75] offset:144
  ds_write_b128 v3, v[76:79] offset:256
  ds_write_b128 v3, v[80:83] offset:272
  ds_write_b128 v3, v[84:87] offset:384
  ds_write_b128 v3, v[88:91] offset:400
  s_mov_b64 exec, -1
M_NEXT:
  s_waitcnt lgkmcnt(0)
  s_barrier
  s_add_u32 s31, s31, s51
M_HEAD:
  v_lshrrev_b32 v2, 3, v0
  v_lshlrev_b32 v30, 4, v2
  s_mul_i32 s40, s3, 1152
  s_add_u32 s40, s40, 5242880
  buffer_load_dwordx4 v[20:23], v30, s[8:11], s40 offen
  v_lshlrev_b32 v3, 4, v0
  v_mov_b32 v92, 0
  v_mov_b32 v93, 0
  v_mov_b32 v94, 0
  v_mov_b32 v95, 0
  v_mov_b32 v96, 0x8000
  v_mov_b32 v97, 0x8000
  v_mov_b32 v98, 0x8000
  v_mov_b32 v99, 0x8000
  v_mov_b32 v100, 2802864768
  v_mov_b32 v101, 2802864768
  v_mov_b32 v102, 2802864768
  v_mov_b32 v103, 2802864768
  v_add_u32 v2, 60800, v3
  ds_write_b128 v2, v[96:99] offset:0
  ds_write_b128 v2, v[96:99] offset:8192
  v_cmp_gt_u32 vcc, 8, v0
  s_nop 0
  s_mov_b64 exec, vcc
  ds_write_b128 v2, v[96:99] offset:16384
  s_mov_b64 exec, -1
  v_add_u32 v2, 43296, v3
  ds_write_b128 v2, v[92:95] offset:0
  v_cmp_gt_u32 vcc, 511, v0
  s_nop 0
  s_mov_b64 exec, vcc
  ds_write_b128 v2, v[92:95] offset:8192
  s_mov_b64 exec, -1
  v_add_u32 v2, 60192, v3
  v_cmp_gt_u32 vcc, 17, v0
  s_nop 0
  s_mov_b64 exec, vcc
  ds_write_b128 v2, v[92:95] offset:0
  s_mov_b64 exec, -1
  v_add_u32 v2, 77312, v3
  v_cmp_gt_u32 vcc, 144, v0
  s_nop 0
  s_mov_b64 exec, vcc
  ds_write_b128 v2, v[100:103] offset:0
  s_mov_b64 exec, -1
  v_bfe_u32 v2, v0, 3, 3
  v_lshlrev_b32 v2, 5, v2
  v_add_u32 v2, s30, v2
  v_mul_u32_u24 v30, 20000, v2
  v_and_b32 v2, 7, v0
  v_lshl_add_u32 v30, v2, 4, v30
  v_lshlrev_b32 v2, 1, v2
  v_sub_u32 v31, s51, v2
  v_add_u32 v2, s31, v2
  s_lshl_b32 s40, s31, 3
  v_mov_b32 v114, 0
  s_waitcnt vmcnt(0)
  v_and_b32 v26, 0xffff, v20
  v_lshrrev_b32 v20, 16, v20
  v_lshl_add_u32 v26, v26, 3, v30
  v_sub_u32 v20, v20, v2
  v_max_i32 v114, v114, v20
  v_min_i32 v20, v20, v31
  v_cmp_lt_i32_e64 s[52:53], 0, v20
  v_cmp_lt_i32_e64 s[54:55], 1, v20
  v_cmp_lt_i32_e64 s[56:57], 16, v20
  v_cmp_lt_i32_e64 s[58:59], 17, v20
  v_and_b32 v27, 0xffff, v21
  v_lshrrev_b32 v21, 16, v21
  v_lshl_add_u32 v27, v27, 3, v30
  v_sub_u32 v21, v21, v2
  v_max_i32 v114, v114, v21
  v_min_i32 v21, v21, v31
  v_cmp_lt_i32_e64 s[60:61], 0, v21
  v_cmp_lt_i32_e64 s[62:63], 1, v21
  v_cmp_lt_i32_e64 s[64:65], 16, v21
  v_cmp_lt_i32_e64 s[66:67], 17, v21
  v_and_b32 v28, 0xffff, v22
  v_lshrrev_b32 v22, 16, v22
  v_lshl_add_u32 v28, v28, 3, v30
  v_sub_u32 v22, v22, v2
  v_max_i32 v114, v114, v22
  v_min_i32 v22, v22, v31
  v_cmp_lt_i32_e64 s[68:69], 0, v22
  v_cmp_lt_i32_e64 s[70:71], 1, v22
  v_cmp_lt_i32_e64 s[72:73], 16, v22
  v_cmp_lt_i32_e64 s[74:75], 17, v22
  v_and_b32 v29, 0xffff, v23
  v_lshrrev_b32 v23, 16, v23
  v_lshl_add_u32 v29, v29, 3, v30
  v_sub_u32 v23, v23, v2
  v_max_i32 v114, v114, v23
  v_min_i32 v23, v23, v31
  v_cmp_lt_i32_e64 s[76:77], 0, v23
  v_cmp_lt_i32_e64 s[78:79], 1, v23
  v_cmp_lt_i32_e64 s[80:81], 16, v23
  v_cmp_lt_i32_e64 s[82:83], 17, v23
  v_mov_b32 v2, 0x40000000
  v_cndmask_b32_e64 v30, v2, v26, s[52:53]
  buffer_load_dwordx4 v[60:63], v30, s[8:11], s40 offen offset:0
  v_cndmask_b32_e64 v31, v2, v26, s[56:57]
  buffer_load_dwordx4 v[64:67], v31, s[8:11], s40 offen offset:128
  s_add_u32 s40, s40, 160000
  v_cndmask_b32_e64 v30, v2, v27, s[60:61]
  buffer_load_dwordx4 v[68:71], v30, s[8:11], s40 offen offset:0
  v_cndmask_b32_e64 v31, v2, v27, s[64:65]
  buffer_load_dwordx4 v[72:75], v31, s[8:11], s40 offen offset:128
  s_add_u32 s40, s40, 160000
  v_cndmask_b32_e64 v30, v2, v28, s[68:69]
  buffer_load_dwordx4 v[76:79], v30, s[8:11], s40 offen offset:0
  v_cndmask_b32_e64 v31, v2, v28, s[72:73]
  buffer_load_dwordx4 v[80:83], v31, s[8:11], s40 offen offset:128
  s_add_u32 s40, s40, 160000
  v_cndmask_b32_e64 v30, v2, v29, s[76:77]
  buffer_load_dwordx4 v[84:87], v30, s[8:11], s40 offen offset:0
  v_cndmask_b32_e64 v31, v2, v29, s[80:81]
  buffer_load_dwordx4 v[88:91], v31, s[8:11], s40 offen offset:128
  s_waitcnt vmcnt(0)
  s_waitcnt lgkmcnt(0)
  s_barrier
  s_branch M_BDONE
.section .rodata,"a"
.p2align 6
.amdhsa_kernel part_kernel
  .amdhsa_next_free_vgpr 44
  .amdhsa_next_free_sgpr 102
  .amdhsa_accum_offset 44
  .amdhsa_group_segment_fixed_size 0
  .amdhsa_kernarg_size 88
  .amdhsa_user_sgpr_count 2
  .amdhsa_user_sgpr_kernarg_segment_ptr 1
  .amdhsa_system_sgpr_workgroup_id_x 1
.end_amdhsa_kernel
.p2align 6
.amdhsa_kernel main_kernel
  .amdhsa_next_free_vgpr 252
  .amdhsa_next_free_sgpr 102
  .amdhsa_accum_offset 124
  .amdhsa_group_segment_fixed_size 0
  .amdhsa_kernarg_size 88
  .amdhsa_user_sgpr_count 2
  .amdhsa_user_sgpr_kernarg_segment_ptr 1
  .amdhsa_system_sgpr_workgroup_id_x 1
.end_amdhsa_kernel
```
